```python
import torch

def _softmax(x, axis=-1):
    return torch.softmax(x, dim=axis)
def _gelu(x):
    return torch.nn.functional.gelu(x, approximate="tanh")
def _silu(x):
    return torch.nn.functional.silu(x)
def _sigmoid(x):
    return torch.sigmoid(x)
def _layernorm(x, axis=-1, eps=1e-5):
    m = x.mean(dim=axis, keepdim=True)
    v = x.var(dim=axis, keepdim=True, unbiased=False)
    return (x - m) / torch.sqrt(v + eps)
def _scatter_add(tgt, idx, src, axis=0):
    return tgt.clone().index_add_(axis, idx, src)
def _segment_sum(src, seg, n):
    out = torch.zeros((n,) + src.shape[1:], dtype=src.dtype)
    return out.index_add_(0, seg, src)
def _pad(x, pw):
    flat = tuple(v for pair in reversed(pw) for v in pair)
    return torch.nn.functional.pad(x, flat)

kernel_name = 'recurrent_scan__sliding_block__dense_activation_squared_relu__prompt'

def setup_inputs():

    _w = (lambda a: (lambda t: t.to(torch.bfloat16) if t.is_floating_point() else t)(torch.as_tensor(a)))
    def _A_setup():
        B, S, D = 1, 2048, 640
        return {
            "x": _w((lambda *s: torch.randn(*s, dtype=torch.bfloat16) * 0.05)(B, S, D)),
            "wqkv": _w((lambda *s: torch.randn(*s, dtype=torch.bfloat16) * 0.05)(D, 3 * D)),
            "wo": _w((lambda *s: torch.randn(*s, dtype=torch.bfloat16) * 0.05)(D, D)),
        }
    _A_in = _A_setup()

    def _B_setup():
        B, S, D, F = 1, 2048, 640, 1536
        return {
            "x": _w((lambda *s: torch.randn(*s, dtype=torch.bfloat16) * 0.05)(B, S, D)),
            "w1": _w((lambda *s: torch.randn(*s, dtype=torch.bfloat16) * 0.05)(D, F)),
            "b1": _w((lambda *s: torch.randn(*s, dtype=torch.bfloat16) * 0.4)(F)),
            "w2": _w((lambda *s: torch.randn(*s, dtype=torch.bfloat16) * 0.05)(F, D)),
            "b2": _w((lambda *s: torch.randn(*s, dtype=torch.bfloat16) * 0.8)(D)),
        }
    _B_in = _B_setup()

    return {
        "A_x": _A_in["x"],
        "A_wqkv": _A_in["wqkv"],
        "A_wo": _A_in["wo"],
        "B_x": _B_in["x"],
        "B_w1": _B_in["w1"],
        "B_b1": _B_in["b1"],
        "B_w2": _B_in["w2"],
        "B_b2": _B_in["b2"],
    }

def reference(A_x, A_wqkv, A_wo, B_x, B_w1, B_b1, B_w2, B_b2):
    def _A_ref(x, wqkv, wo):
        B, S, D = x.shape
        H = 32; Dh = D // H; W = 256
        qkv = (lambda x, *d: x.permute(*d))((x @ wqkv).reshape(B, S, 3, H, Dh), 2, 0, 3, 1, 4)
        q, k, v = qkv[0], qkv[1], qkv[2]
        scores = torch.einsum("bhqd,bhkd->bhqk", q, k) * (Dh ** -0.5)
        idx = torch.arange(S)
        mask = (idx[:, None] - idx[None, :] >= 0) & (idx[:, None] - idx[None, :] < W)
        scores = torch.where(mask[None, None], scores, -1e9)
        p = _softmax(scores, axis=-1)
        o = torch.einsum("bhqk,bhkd->bhqd", p, v)
        return (lambda x, *d: x.permute(*d))(o, 0, 2, 1, 3).reshape(B, S, D) @ wo

    def _B_ref(x, w1, b1, w2, b2):
        h = torch.einsum("bsd,df->bsf", x, w1) + b1
        zero = torch.zeros_like(h)
        r = torch.where(h > zero, h, zero)
        h = r * r
        out = torch.einsum("bsf,fd->bsd", h, w2) + b2
        return out

    x = A_x
    xn = _layernorm(x, axis=-1)
    s = _A_ref(xn, A_wqkv, A_wo)
    g = _silu(_B_ref(xn, B_w1, B_b1, B_w2, B_b2))
    return x + s * g
```

```asm
; @launch kernel=k1_kernel grid=(256,1,1) block=(512,1,1) lds=163840
; @launch kernel=k23_kernel grid=(256,1,1) block=(512,1,1) lds=102656
.amdgcn_target "amdgcn-amd-amdhsa--gfx950"
.text
.globl k1_kernel
.p2align 8
.type k1_kernel,@function
k1_kernel:
    s_cmp_ge_u32 s2, 256
    s_cbranch_scc1 K1_END
    s_load_dwordx4 s[4:7], s[0:1], 0
    s_load_dwordx2 s[20:21], s[0:1], 16
    s_load_dwordx4 s[24:27], s[0:1], 32
    s_load_dwordx2 s[28:29], s[0:1], 48
    s_load_dwordx2 s[30:31], s[0:1], 80
    s_and_b32 s32, s2, 7
    s_lshr_b32 s80, s2, 3
    s_add_u32 s33, s80, 28
    s_and_b32 s33, s33, 31
    s_load_dwordx2 s[82:83], s[0:1], 72
    s_lshr_b32 s34, s32, 1
    s_and_b32 s35, s32, 1
    s_lshr_b32 s36, s33, 2
    s_and_b32 s37, s33, 3
    s_mul_i32 s38, s34, 7
    s_add_u32 s38, s38, s36
    s_lshl_b32 s39, s35, 5
    s_lshl_b32 s40, s37, 3
    s_add_u32 s39, s39, s40
    v_and_b32 v243, 63, v0
    v_lshrrev_b32 v1, 6, v0
    s_nop 0
    v_readfirstlane_b32 s78, v1
    s_and_b32 s41, s78, 3
    s_mul_i32 s49, s39, 40960
    s_mul_i32 s50, s41, 10240
    s_waitcnt lgkmcnt(0)
    s_cmp_ge_u32 s36, 7
    s_cbranch_scc1 K1_HELP
    s_cmp_ge_u32 s38, 27
    s_cbranch_scc1 K1_HELP
    s_mov_b32 s12, s4
    s_and_b32 s13, s5, 0xffff
    s_mov_b32 s14, 0x280000
    s_mov_b32 s15, 0x00020000
    s_mov_b32 s16, s30
    s_and_b32 s17, s31, 0xffff
    s_mov_b32 s18, 0x2000000
    s_mov_b32 s19, 0x00020000
    s_lshl_b32 s79, s41, 3
    s_mul_i32 s81, s37, 3
    s_add_u32 s81, s81, s36
    s_cmp_ge_u32 s81, 10
    s_cbranch_scc0 K1_O0
    s_sub_u32 s81, s81, 10
K1_O0:
    s_lshl_b32 s77, s81, 3
    s_cmp_ge_u32 s78, 4
    s_cbranch_scc1 K1_LOAD
    s_setprio 2
    v_bfe_u32 v1, v243, 2, 2
    v_lshrrev_b32 v2, 5, v243
    v_lshl_add_u32 v2, v2, 3, v1
    v_lshlrev_b32 v2, 8, v2
    v_xor_b32 v1, s41, v1
    v_lshl_add_u32 v2, v1, 6, v2
    v_bfe_u32 v1, v243, 4, 1
    v_lshl_add_u32 v2, v1, 5, v2
    v_and_b32 v1, 3, v243
    v_lshl_add_u32 v2, v1, 3, v2
    v_add_u32 v236, 81920, v2
    v_add_u32 v237, 122880, v2
    v_and_b32 v1, 31, v243
    v_lshrrev_b32 v2, 5, v243
    v_and_b32 v3, 15, v1
    v_mul_u32_u24 v4, 1280, v1
    v_add_u32 v5, 0, v2
    v_xor_b32 v5, v5, v3
    v_lshl_add_u32 v224, v5, 4, v4
    v_add_u32 v5, 2, v2
    v_xor_b32 v5, v5, v3
    v_lshl_add_u32 v225, v5, 4, v4
    v_add_u32 v5, 4, v2
    v_xor_b32 v5, v5, v3
    v_lshl_add_u32 v226, v5, 4, v4
    v_add_u32 v5, 6, v2
    v_xor_b32 v5, v5, v3
    v_lshl_add_u32 v227, v5, 4, v4
    v_add_u32 v5, 8, v2
    v_xor_b32 v5, v5, v3
    v_lshl_add_u32 v228, v5, 4, v4
    v_add_u32 v5, 10, v2
    v_xor_b32 v5, v5, v3
    v_lshl_add_u32 v229, v5, 4, v4
    v_add_u32 v5, 12, v2
    v_xor_b32 v5, v5, v3
    v_lshl_add_u32 v230, v5, 4, v4
    v_add_u32 v5, 14, v2
    v_xor_b32 v5, v5, v3
    v_lshl_add_u32 v231, v5, 4, v4
    v_mov_b32 v239, 0x3f803f80
    v_mov_b32 v238, 0
    s_cmp_lt_u32 s38, 10
    s_cbranch_scc1 K1_QK
    s_cmp_lt_u32 s38, 15
    s_cbranch_scc1 K1_V
K1_H:
    v_and_b32 v10, 31, v243
    v_lshrrev_b32 v11, 5, v243
    s_mov_b32 s64, s26
    s_and_b32 s65, s27, 0xffff
    s_mov_b32 s66, 0xc00
    s_mov_b32 s67, 0x00020000
    s_sub_u32 s57, s38, 15
    s_lshl_b32 s57, s57, 2
    s_add_u32 s57, s57, s41
    s_lshl_b32 s58, s57, 6
    v_lshlrev_b32 v12, 1, v10
    buffer_load_ushort v15, v12, s[64:67], s58 offen
    v_lshrrev_b32 v12, 4, v10
    v_mul_u32_u24 v12, 50176, v12
    v_and_b32 v13, 15, v10
    v_lshl_add_u32 v12, v13, 4, v12
    v_lshl_add_u32 v232, v11, 8, v12
    s_mul_i32 s59, s39, 100352
    s_lshl_b32 s58, s57, 10
    s_add_u32 s59, s59, s58
    s_add_u32 s59, s59, 12582912
    s_mov_b32 s60, 100352
    v_lshlrev_b32 v254, 2, v10
    v_add_u32 v254, 155648, v254
    s_lshl_b32 s51, s41, 7
    s_add_u32 s51, s51, 157696
    v_lshlrev_b32 v255, 4, v11
    v_add_u32 v255, s51, v255
    v_lshlrev_b32 v252, 2, v10
    v_add_u32 v252, s51, v252
    s_waitcnt vmcnt(0)
    v_lshlrev_b32 v15, 16, v15
    ds_write_b32 v252, v15 offset:512
    s_barrier
    ds_read_b64_tr_b16 v[0:1], v237 offset:0
    ds_read_b64_tr_b16 v[2:3], v237 offset:1024
    ds_read_b64_tr_b16 v[4:5], v237 offset:4096
    ds_read_b64_tr_b16 v[6:7], v237 offset:5120
    ds_read_b64_tr_b16 v[8:9], v237 offset:8192
    ds_read_b64_tr_b16 v[10:11], v237 offset:9216
    ds_read_b64_tr_b16 v[12:13], v237 offset:12288
    ds_read_b64_tr_b16 v[14:15], v237 offset:13312
    ds_read_b128 v[192:195], v224 offset:0
    ds_read_b128 v[196:199], v225 offset:0
    ds_read_b128 v[200:203], v226 offset:0
    ds_read_b128 v[204:207], v227 offset:0
    ds_read_b128 v[208:211], v224 offset:40960
    ds_read_b128 v[212:215], v225 offset:40960
    ds_read_b128 v[216:219], v226 offset:40960
    ds_read_b128 v[220:223], v227 offset:40960
    s_waitcnt lgkmcnt(8)
    s_barrier
    ds_read_b64_tr_b16 v[16:17], v237 offset:16384
    ds_read_b64_tr_b16 v[18:19], v237 offset:17408
    ds_read_b64_tr_b16 v[20:21], v237 offset:20480
    ds_read_b64_tr_b16 v[22:23], v237 offset:21504
    ds_read_b64_tr_b16 v[24:25], v237 offset:24576
    ds_read_b64_tr_b16 v[26:27], v237 offset:25600
    ds_read_b64_tr_b16 v[28:29], v237 offset:28672
    ds_read_b64_tr_b16 v[30:31], v237 offset:29696
    s_waitcnt lgkmcnt(8)
    v_dot2c_f32_bf16 v238, v239, v0
    v_dot2c_f32_bf16 v238, v239, v1
    v_dot2c_f32_bf16 v238, v239, v2
    v_dot2c_f32_bf16 v238, v239, v3
    v_dot2c_f32_bf16 v238, v239, v4
    v_dot2c_f32_bf16 v238, v239, v5
    v_dot2c_f32_bf16 v238, v239, v6
    v_dot2c_f32_bf16 v238, v239, v7
    v_dot2c_f32_bf16 v238, v239, v8
    v_dot2c_f32_bf16 v238, v239, v9
    v_dot2c_f32_bf16 v238, v239, v10
    v_dot2c_f32_bf16 v238, v239, v11
    v_dot2c_f32_bf16 v238, v239, v12
    v_dot2c_f32_bf16 v238, v239, v13
    v_dot2c_f32_bf16 v238, v239, v14
    v_dot2c_f32_bf16 v238, v239, v15
    v_mfma_f32_32x32x16_bf16 v[160:175], v[0:3], v[192:195], 0
    ds_read_b128 v[192:195], v228 offset:0
    v_mfma_f32_32x32x16_bf16 v[176:191], v[0:3], v[208:211], 0
    ds_read_b128 v[208:211], v228 offset:40960
    v_mfma_f32_32x32x16_bf16 v[160:175], v[4:7], v[196:199], v[160:175]
    ds_read_b128 v[196:199], v229 offset:0
    v_mfma_f32_32x32x16_bf16 v[176:191], v[4:7], v[212:215], v[176:191]
    ds_read_b128 v[212:215], v229 offset:40960
    v_mfma_f32_32x32x16_bf16 v[160:175], v[8:11], v[200:203], v[160:175]
    ds_read_b128 v[200:203], v230 offset:0
    v_mfma_f32_32x32x16_bf16 v[176:191], v[8:11], v[216:219], v[176:191]
    ds_read_b128 v[216:219], v230 offset:40960
    v_mfma_f32_32x32x16_bf16 v[160:175], v[12:15], v[204:207], v[160:175]
    ds_read_b128 v[204:207], v231 offset:0
    v_mfma_f32_32x32x16_bf16 v[176:191], v[12:15], v[220:223], v[176:191]
    ds_read_b128 v[220:223], v231 offset:40960
    s_waitcnt lgkmcnt(8)
    s_barrier
    ds_read_b64_tr_b16 v[32:33], v236 offset:0
    ds_read_b64_tr_b16 v[34:35], v236 offset:1024
    ds_read_b64_tr_b16 v[36:37], v236 offset:4096
    ds_read_b64_tr_b16 v[38:39], v236 offset:5120
    ds_read_b64_tr_b16 v[40:41], v236 offset:8192
    ds_read_b64_tr_b16 v[42:43], v236 offset:9216
    ds_read_b64_tr_b16 v[44:45], v236 offset:12288
    ds_read_b64_tr_b16 v[46:47], v236 offset:13312
    s_waitcnt lgkmcnt(8)
    v_dot2c_f32_bf16 v238, v239, v16
    v_dot2c_f32_bf16 v238, v239, v17
    v_dot2c_f32_bf16 v238, v239, v18
    v_dot2c_f32_bf16 v238, v239, v19
    v_dot2c_f32_bf16 v238, v239, v20
    v_dot2c_f32_bf16 v238, v239, v21
    v_dot2c_f32_bf16 v238, v239, v22
    v_dot2c_f32_bf16 v238, v239, v23
    v_dot2c_f32_bf16 v238, v239, v24
    v_dot2c_f32_bf16 v238, v239, v25
    v_dot2c_f32_bf16 v238, v239, v26
    v_dot2c_f32_bf16 v238, v239, v27
    v_dot2c_f32_bf16 v238, v239, v28
    v_dot2c_f32_bf16 v238, v239, v29
    v_dot2c_f32_bf16 v238, v239, v30
    v_dot2c_f32_bf16 v238, v239, v31
    v_mfma_f32_32x32x16_bf16 v[160:175], v[16:19], v[192:195], v[160:175]
    ds_read_b128 v[192:195], v224 offset:256
    v_mfma_f32_32x32x16_bf16 v[176:191], v[16:19], v[208:211], v[176:191]
    ds_read_b128 v[208:211], v224 offset:41216
    v_mfma_f32_32x32x16_bf16 v[160:175], v[20:23], v[196:199], v[160:175]
    ds_read_b128 v[196:199], v225 offset:256
    v_mfma_f32_32x32x16_bf16 v[176:191], v[20:23], v[212:215], v[176:191]
    ds_read_b128 v[212:215], v225 offset:41216
    v_mfma_f32_32x32x16_bf16 v[160:175], v[24:27], v[200:203], v[160:175]
    ds_read_b128 v[200:203], v226 offset:256
    v_mfma_f32_32x32x16_bf16 v[176:191], v[24:27], v[216:219], v[176:191]
    ds_read_b128 v[216:219], v226 offset:41216
    v_mfma_f32_32x32x16_bf16 v[160:175], v[28:31], v[204:207], v[160:175]
    ds_read_b128 v[204:207], v227 offset:256
    v_mfma_f32_32x32x16_bf16 v[176:191], v[28:31], v[220:223], v[176:191]
    ds_read_b128 v[220:223], v227 offset:41216
    s_waitcnt lgkmcnt(8)
    s_barrier
    ds_read_b64_tr_b16 v[48:49], v236 offset:16384
    ds_read_b64_tr_b16 v[50:51], v236 offset:17408
    ds_read_b64_tr_b16 v[52:53], v236 offset:20480
    ds_read_b64_tr_b16 v[54:55], v236 offset:21504
    ds_read_b64_tr_b16 v[56:57], v236 offset:24576
    ds_read_b64_tr_b16 v[58:59], v236 offset:25600
    ds_read_b64_tr_b16 v[60:61], v236 offset:28672
    ds_read_b64_tr_b16 v[62:63], v236 offset:29696
    s_waitcnt lgkmcnt(8)
    v_dot2c_f32_bf16 v238, v239, v32
    v_dot2c_f32_bf16 v238, v239, v33
    v_dot2c_f32_bf16 v238, v239, v34
    v_dot2c_f32_bf16 v238, v239, v35
    v_dot2c_f32_bf16 v238, v239, v36
    v_dot2c_f32_bf16 v238, v239, v37
    v_dot2c_f32_bf16 v238, v239, v38
    v_dot2c_f32_bf16 v238, v239, v39
    v_dot2c_f32_bf16 v238, v239, v40
    v_dot2c_f32_bf16 v238, v239, v41
    v_dot2c_f32_bf16 v238, v239, v42
    v_dot2c_f32_bf16 v238, v239, v43
    v_dot2c_f32_bf16 v238, v239, v44
    v_dot2c_f32_bf16 v238, v239, v45
    v_dot2c_f32_bf16 v238, v239, v46
    v_dot2c_f32_bf16 v238, v239, v47
    v_mfma_f32_32x32x16_bf16 v[160:175], v[32:35], v[192:195], v[160:175]
    ds_read_b128 v[192:195], v228 offset:256
    v_mfma_f32_32x32x16_bf16 v[176:191], v[32:35], v[208:211], v[176:191]
    ds_read_b128 v[208:211], v228 offset:41216
    v_mfma_f32_32x32x16_bf16 v[160:175], v[36:39], v[196:199], v[160:175]
    ds_read_b128 v[196:199], v229 offset:256
    v_mfma_f32_32x32x16_bf16 v[176:191], v[36:39], v[212:215], v[176:191]
    ds_read_b128 v[212:215], v229 offset:41216
    v_mfma_f32_32x32x16_bf16 v[160:175], v[40:43], v[200:203], v[160:175]
    ds_read_b128 v[200:203], v230 offset:256
    v_mfma_f32_32x32x16_bf16 v[176:191], v[40:43], v[216:219], v[176:191]
    ds_read_b128 v[216:219], v230 offset:41216
    v_mfma_f32_32x32x16_bf16 v[160:175], v[44:47], v[204:207], v[160:175]
    ds_read_b128 v[204:207], v231 offset:256
    v_mfma_f32_32x32x16_bf16 v[176:191], v[44:47], v[220:223], v[176:191]
    ds_read_b128 v[220:223], v231 offset:41216
    s_waitcnt lgkmcnt(8)
    s_barrier
    ds_read_b64_tr_b16 v[64:65], v237 offset:0
    ds_read_b64_tr_b16 v[66:67], v237 offset:1024
    ds_read_b64_tr_b16 v[68:69], v237 offset:4096
    ds_read_b64_tr_b16 v[70:71], v237 offset:5120
    ds_read_b64_tr_b16 v[72:73], v237 offset:8192
    ds_read_b64_tr_b16 v[74:75], v237 offset:9216
    ds_read_b64_tr_b16 v[76:77], v237 offset:12288
    ds_read_b64_tr_b16 v[78:79], v237 offset:13312
    s_waitcnt lgkmcnt(8)
    v_dot2c_f32_bf16 v238, v239, v48
    v_dot2c_f32_bf16 v238, v239, v49
    v_dot2c_f32_bf16 v238, v239, v50
    v_dot2c_f32_bf16 v238, v239, v51
    v_dot2c_f32_bf16 v238, v239, v52
    v_dot2c_f32_bf16 v238, v239, v53
    v_dot2c_f32_bf16 v238, v239, v54
    v_dot2c_f32_bf16 v238, v239, v55
    v_dot2c_f32_bf16 v238, v239, v56
    v_dot2c_f32_bf16 v238, v239, v57
    v_dot2c_f32_bf16 v238, v239, v58
    v_dot2c_f32_bf16 v238, v239, v59
    v_dot2c_f32_bf16 v238, v239, v60
    v_dot2c_f32_bf16 v238, v239, v61
    v_dot2c_f32_bf16 v238, v239, v62
    v_dot2c_f32_bf16 v238, v239, v63
    v_mfma_f32_32x32x16_bf16 v[160:175], v[48:51], v[192:195], v[160:175]
    ds_read_b128 v[192:195], v224 offset:512
    v_mfma_f32_32x32x16_bf16 v[176:191], v[48:51], v[208:211], v[176:191]
    ds_read_b128 v[208:211], v224 offset:41472
    v_mfma_f32_32x32x16_bf16 v[160:175], v[52:55], v[196:199], v[160:175]
    ds_read_b128 v[196:199], v225 offset:512
    v_mfma_f32_32x32x16_bf16 v[176:191], v[52:55], v[212:215], v[176:191]
    ds_read_b128 v[212:215], v225 offset:41472
    v_mfma_f32_32x32x16_bf16 v[160:175], v[56:59], v[200:203], v[160:175]
    ds_read_b128 v[200:203], v226 offset:512
    v_mfma_f32_32x32x16_bf16 v[176:191], v[56:59], v[216:219], v[176:191]
    ds_read_b128 v[216:219], v226 offset:41472
    v_mfma_f32_32x32x16_bf16 v[160:175], v[60:63], v[204:207], v[160:175]
    ds_read_b128 v[204:207], v227 offset:512
    v_mfma_f32_32x32x16_bf16 v[176:191], v[60:63], v[220:223], v[176:191]
    ds_read_b128 v[220:223], v227 offset:41472
    s_waitcnt lgkmcnt(8)
    s_barrier
    ds_read_b64_tr_b16 v[80:81], v237 offset:16384
    ds_read_b64_tr_b16 v[82:83], v237 offset:17408
    ds_read_b64_tr_b16 v[84:85], v237 offset:20480
    ds_read_b64_tr_b16 v[86:87], v237 offset:21504
    ds_read_b64_tr_b16 v[88:89], v237 offset:24576
    ds_read_b64_tr_b16 v[90:91], v237 offset:25600
    ds_read_b64_tr_b16 v[92:93], v237 offset:28672
    ds_read_b64_tr_b16 v[94:95], v237 offset:29696
    s_waitcnt lgkmcnt(8)
    v_dot2c_f32_bf16 v238, v239, v64
    v_dot2c_f32_bf16 v238, v239, v65
    v_dot2c_f32_bf16 v238, v239, v66
    v_dot2c_f32_bf16 v238, v239, v67
    v_dot2c_f32_bf16 v238, v239, v68
    v_dot2c_f32_bf16 v238, v239, v69
    v_dot2c_f32_bf16 v238, v239, v70
    v_dot2c_f32_bf16 v238, v239, v71
    v_dot2c_f32_bf16 v238, v239, v72
    v_dot2c_f32_bf16 v238, v239, v73
    v_dot2c_f32_bf16 v238, v239, v74
    v_dot2c_f32_bf16 v238, v239, v75
    v_dot2c_f32_bf16 v238, v239, v76
    v_dot2c_f32_bf16 v238, v239, v77
    v_dot2c_f32_bf16 v238, v239, v78
    v_dot2c_f32_bf16 v238, v239, v79
    v_mfma_f32_32x32x16_bf16 v[160:175], v[64:67], v[192:195], v[160:175]
    ds_read_b128 v[192:195], v228 offset:512
    v_mfma_f32_32x32x16_bf16 v[176:191], v[64:67], v[208:211], v[176:191]
    ds_read_b128 v[208:211], v228 offset:41472
    v_mfma_f32_32x32x16_bf16 v[160:175], v[68:71], v[196:199], v[160:175]
    ds_read_b128 v[196:199], v229 offset:512
    v_mfma_f32_32x32x16_bf16 v[176:191], v[68:71], v[212:215], v[176:191]
    ds_read_b128 v[212:215], v229 offset:41472
    v_mfma_f32_32x32x16_bf16 v[160:175], v[72:75], v[200:203], v[160:175]
    ds_read_b128 v[200:203], v230 offset:512
    v_mfma_f32_32x32x16_bf16 v[176:191], v[72:75], v[216:219], v[176:191]
    ds_read_b128 v[216:219], v230 offset:41472
    v_mfma_f32_32x32x16_bf16 v[160:175], v[76:79], v[204:207], v[160:175]
    ds_read_b128 v[204:207], v231 offset:512
    v_mfma_f32_32x32x16_bf16 v[176:191], v[76:79], v[220:223], v[176:191]
    ds_read_b128 v[220:223], v231 offset:41472
    s_waitcnt lgkmcnt(8)
    s_barrier
    ds_read_b64_tr_b16 v[96:97], v236 offset:0
    ds_read_b64_tr_b16 v[98:99], v236 offset:1024
    ds_read_b64_tr_b16 v[100:101], v236 offset:4096
    ds_read_b64_tr_b16 v[102:103], v236 offset:5120
    ds_read_b64_tr_b16 v[104:105], v236 offset:8192
    ds_read_b64_tr_b16 v[106:107], v236 offset:9216
    ds_read_b64_tr_b16 v[108:109], v236 offset:12288
    ds_read_b64_tr_b16 v[110:111], v236 offset:13312
    s_waitcnt lgkmcnt(8)
    v_dot2c_f32_bf16 v238, v239, v80
    v_dot2c_f32_bf16 v238, v239, v81
    v_dot2c_f32_bf16 v238, v239, v82
    v_dot2c_f32_bf16 v238, v239, v83
    v_dot2c_f32_bf16 v238, v239, v84
    v_dot2c_f32_bf16 v238, v239, v85
    v_dot2c_f32_bf16 v238, v239, v86
    v_dot2c_f32_bf16 v238, v239, v87
    v_dot2c_f32_bf16 v238, v239, v88
    v_dot2c_f32_bf16 v238, v239, v89
    v_dot2c_f32_bf16 v238, v239, v90
    v_dot2c_f32_bf16 v238, v239, v91
    v_dot2c_f32_bf16 v238, v239, v92
    v_dot2c_f32_bf16 v238, v239, v93
    v_dot2c_f32_bf16 v238, v239, v94
    v_dot2c_f32_bf16 v238, v239, v95
    v_mfma_f32_32x32x16_bf16 v[160:175], v[80:83], v[192:195], v[160:175]
    ds_read_b128 v[192:195], v224 offset:768
    v_mfma_f32_32x32x16_bf16 v[176:191], v[80:83], v[208:211], v[176:191]
    ds_read_b128 v[208:211], v224 offset:41728
    v_mfma_f32_32x32x16_bf16 v[160:175], v[84:87], v[196:199], v[160:175]
    ds_read_b128 v[196:199], v225 offset:768
    v_mfma_f32_32x32x16_bf16 v[176:191], v[84:87], v[212:215], v[176:191]
    ds_read_b128 v[212:215], v225 offset:41728
    v_mfma_f32_32x32x16_bf16 v[160:175], v[88:91], v[200:203], v[160:175]
    ds_read_b128 v[200:203], v226 offset:768
    v_mfma_f32_32x32x16_bf16 v[176:191], v[88:91], v[216:219], v[176:191]
    ds_read_b128 v[216:219], v226 offset:41728
    v_mfma_f32_32x32x16_bf16 v[160:175], v[92:95], v[204:207], v[160:175]
    ds_read_b128 v[204:207], v227 offset:768
    v_mfma_f32_32x32x16_bf16 v[176:191], v[92:95], v[220:223], v[176:191]
    ds_read_b128 v[220:223], v227 offset:41728
    s_waitcnt lgkmcnt(8)
    s_barrier
    ds_read_b64_tr_b16 v[112:113], v236 offset:16384
    ds_read_b64_tr_b16 v[114:115], v236 offset:17408
    ds_read_b64_tr_b16 v[116:117], v236 offset:20480
    ds_read_b64_tr_b16 v[118:119], v236 offset:21504
    ds_read_b64_tr_b16 v[120:121], v236 offset:24576
    ds_read_b64_tr_b16 v[122:123], v236 offset:25600
    ds_read_b64_tr_b16 v[124:125], v236 offset:28672
    ds_read_b64_tr_b16 v[126:127], v236 offset:29696
    s_waitcnt lgkmcnt(8)
    v_dot2c_f32_bf16 v238, v239, v96
    v_dot2c_f32_bf16 v238, v239, v97
    v_dot2c_f32_bf16 v238, v239, v98
    v_dot2c_f32_bf16 v238, v239, v99
    v_dot2c_f32_bf16 v238, v239, v100
    v_dot2c_f32_bf16 v238, v239, v101
    v_dot2c_f32_bf16 v238, v239, v102
    v_dot2c_f32_bf16 v238, v239, v103
    v_dot2c_f32_bf16 v238, v239, v104
    v_dot2c_f32_bf16 v238, v239, v105
    v_dot2c_f32_bf16 v238, v239, v106
    v_dot2c_f32_bf16 v238, v239, v107
    v_dot2c_f32_bf16 v238, v239, v108
    v_dot2c_f32_bf16 v238, v239, v109
    v_dot2c_f32_bf16 v238, v239, v110
    v_dot2c_f32_bf16 v238, v239, v111
    v_mfma_f32_32x32x16_bf16 v[160:175], v[96:99], v[192:195], v[160:175]
    ds_read_b128 v[192:195], v228 offset:768
    v_mfma_f32_32x32x16_bf16 v[176:191], v[96:99], v[208:211], v[176:191]
    ds_read_b128 v[208:211], v228 offset:41728
    v_mfma_f32_32x32x16_bf16 v[160:175], v[100:103], v[196:199], v[160:175]
    ds_read_b128 v[196:199], v229 offset:768
    v_mfma_f32_32x32x16_bf16 v[176:191], v[100:103], v[212:215], v[176:191]
    ds_read_b128 v[212:215], v229 offset:41728
    v_mfma_f32_32x32x16_bf16 v[160:175], v[104:107], v[200:203], v[160:175]
    ds_read_b128 v[200:203], v230 offset:768
    v_mfma_f32_32x32x16_bf16 v[176:191], v[104:107], v[216:219], v[176:191]
    ds_read_b128 v[216:219], v230 offset:41728
    v_mfma_f32_32x32x16_bf16 v[160:175], v[108:111], v[204:207], v[160:175]
    ds_read_b128 v[204:207], v231 offset:768
    v_mfma_f32_32x32x16_bf16 v[176:191], v[108:111], v[220:223], v[176:191]
    ds_read_b128 v[220:223], v231 offset:41728
    s_waitcnt lgkmcnt(8)
    s_barrier
    ds_read_b64_tr_b16 v[128:129], v237 offset:0
    ds_read_b64_tr_b16 v[130:131], v237 offset:1024
    ds_read_b64_tr_b16 v[132:133], v237 offset:4096
    ds_read_b64_tr_b16 v[134:135], v237 offset:5120
    ds_read_b64_tr_b16 v[136:137], v237 offset:8192
    ds_read_b64_tr_b16 v[138:139], v237 offset:9216
    ds_read_b64_tr_b16 v[140:141], v237 offset:12288
    ds_read_b64_tr_b16 v[142:143], v237 offset:13312
    s_waitcnt lgkmcnt(8)
    v_dot2c_f32_bf16 v238, v239, v112
    v_dot2c_f32_bf16 v238, v239, v113
    v_dot2c_f32_bf16 v238, v239, v114
    v_dot2c_f32_bf16 v238, v239, v115
    v_dot2c_f32_bf16 v238, v239, v116
    v_dot2c_f32_bf16 v238, v239, v117
    v_dot2c_f32_bf16 v238, v239, v118
    v_dot2c_f32_bf16 v238, v239, v119
    v_dot2c_f32_bf16 v238, v239, v120
    v_dot2c_f32_bf16 v238, v239, v121
    v_dot2c_f32_bf16 v238, v239, v122
    v_dot2c_f32_bf16 v238, v239, v123
    v_dot2c_f32_bf16 v238, v239, v124
    v_dot2c_f32_bf16 v238, v239, v125
    v_dot2c_f32_bf16 v238, v239, v126
    v_dot2c_f32_bf16 v238, v239, v127
    v_mfma_f32_32x32x16_bf16 v[160:175], v[112:115], v[192:195], v[160:175]
    ds_read_b128 v[192:195], v224 offset:1024
    v_mfma_f32_32x32x16_bf16 v[176:191], v[112:115], v[208:211], v[176:191]
    ds_read_b128 v[208:211], v224 offset:41984
    v_mfma_f32_32x32x16_bf16 v[160:175], v[116:119], v[196:199], v[160:175]
    ds_read_b128 v[196:199], v225 offset:1024
    v_mfma_f32_32x32x16_bf16 v[176:191], v[116:119], v[212:215], v[176:191]
    ds_read_b128 v[212:215], v225 offset:41984
    v_mfma_f32_32x32x16_bf16 v[160:175], v[120:123], v[200:203], v[160:175]
    ds_read_b128 v[200:203], v226 offset:1024
    v_mfma_f32_32x32x16_bf16 v[176:191], v[120:123], v[216:219], v[176:191]
    ds_read_b128 v[216:219], v226 offset:41984
    v_mfma_f32_32x32x16_bf16 v[160:175], v[124:127], v[204:207], v[160:175]
    ds_read_b128 v[204:207], v227 offset:1024
    v_mfma_f32_32x32x16_bf16 v[176:191], v[124:127], v[220:223], v[176:191]
    ds_read_b128 v[220:223], v227 offset:41984
    s_waitcnt lgkmcnt(8)
    s_barrier
    ds_read_b64_tr_b16 v[144:145], v237 offset:16384
    ds_read_b64_tr_b16 v[146:147], v237 offset:17408
    ds_read_b64_tr_b16 v[148:149], v237 offset:20480
    ds_read_b64_tr_b16 v[150:151], v237 offset:21504
    ds_read_b64_tr_b16 v[152:153], v237 offset:24576
    ds_read_b64_tr_b16 v[154:155], v237 offset:25600
    ds_read_b64_tr_b16 v[156:157], v237 offset:28672
    ds_read_b64_tr_b16 v[158:159], v237 offset:29696
    s_waitcnt lgkmcnt(8)
    v_dot2c_f32_bf16 v238, v239, v128
    v_dot2c_f32_bf16 v238, v239, v129
    v_dot2c_f32_bf16 v238, v239, v130
    v_dot2c_f32_bf16 v238, v239, v131
    v_dot2c_f32_bf16 v238, v239, v132
    v_dot2c_f32_bf16 v238, v239, v133
    v_dot2c_f32_bf16 v238, v239, v134
    v_dot2c_f32_bf16 v238, v239, v135
    v_dot2c_f32_bf16 v238, v239, v136
    v_dot2c_f32_bf16 v238, v239, v137
    v_dot2c_f32_bf16 v238, v239, v138
    v_dot2c_f32_bf16 v238, v239, v139
    v_dot2c_f32_bf16 v238, v239, v140
    v_dot2c_f32_bf16 v238, v239, v141
    v_dot2c_f32_bf16 v238, v239, v142
    v_dot2c_f32_bf16 v238, v239, v143
    v_mfma_f32_32x32x16_bf16 v[160:175], v[128:131], v[192:195], v[160:175]
    ds_read_b128 v[192:195], v228 offset:1024
    v_mfma_f32_32x32x16_bf16 v[176:191], v[128:131], v[208:211], v[176:191]
    ds_read_b128 v[208:211], v228 offset:41984
    v_mfma_f32_32x32x16_bf16 v[160:175], v[132:135], v[196:199], v[160:175]
    ds_read_b128 v[196:199], v229 offset:1024
    v_mfma_f32_32x32x16_bf16 v[176:191], v[132:135], v[212:215], v[176:191]
    ds_read_b128 v[212:215], v229 offset:41984
    v_mfma_f32_32x32x16_bf16 v[160:175], v[136:139], v[200:203], v[160:175]
    ds_read_b128 v[200:203], v230 offset:1024
    v_mfma_f32_32x32x16_bf16 v[176:191], v[136:139], v[216:219], v[176:191]
    ds_read_b128 v[216:219], v230 offset:41984
    v_mfma_f32_32x32x16_bf16 v[160:175], v[140:143], v[204:207], v[160:175]
    ds_read_b128 v[204:207], v231 offset:1024
    v_mfma_f32_32x32x16_bf16 v[176:191], v[140:143], v[220:223], v[176:191]
    ds_read_b128 v[220:223], v231 offset:41984
    s_waitcnt lgkmcnt(8)
    s_waitcnt lgkmcnt(0)
    v_dot2c_f32_bf16 v238, v239, v144
    v_dot2c_f32_bf16 v238, v239, v145
    v_dot2c_f32_bf16 v238, v239, v146
    v_dot2c_f32_bf16 v238, v239, v147
    v_dot2c_f32_bf16 v238, v239, v148
    v_dot2c_f32_bf16 v238, v239, v149
    v_dot2c_f32_bf16 v238, v239, v150
    v_dot2c_f32_bf16 v238, v239, v151
    v_dot2c_f32_bf16 v238, v239, v152
    v_dot2c_f32_bf16 v238, v239, v153
    v_dot2c_f32_bf16 v238, v239, v154
    v_dot2c_f32_bf16 v238, v239, v155
    v_dot2c_f32_bf16 v238, v239, v156
    v_dot2c_f32_bf16 v238, v239, v157
    v_dot2c_f32_bf16 v238, v239, v158
    v_dot2c_f32_bf16 v238, v239, v159
    v_mfma_f32_32x32x16_bf16 v[160:175], v[144:147], v[192:195], v[160:175]
    v_mfma_f32_32x32x16_bf16 v[176:191], v[144:147], v[208:211], v[176:191]
    v_mfma_f32_32x32x16_bf16 v[160:175], v[148:151], v[196:199], v[160:175]
    v_mfma_f32_32x32x16_bf16 v[176:191], v[148:151], v[212:215], v[176:191]
    v_mfma_f32_32x32x16_bf16 v[160:175], v[152:155], v[200:203], v[160:175]
    v_mfma_f32_32x32x16_bf16 v[176:191], v[152:155], v[216:219], v[176:191]
    v_mfma_f32_32x32x16_bf16 v[160:175], v[156:159], v[204:207], v[160:175]
    v_mfma_f32_32x32x16_bf16 v[176:191], v[156:159], v[220:223], v[176:191]
    s_waitcnt lgkmcnt(0)
    s_barrier
    s_nop 2
    v_mov_b32 v240, v238
    s_nop 1
    v_permlane32_swap_b32 v238, v240
    s_nop 1
    v_add_f32 v238, v238, v240
    ds_write_b32 v252, v238
    s_waitcnt lgkmcnt(0)
    s_mov_b32 s61, s59
    s_nop 7
    s_nop 7
    ds_read2_b32 v[252:253], v254 offset0:0 offset1:32
    ds_read_b128 v[244:247], v255 offset:0
    ds_read_b128 v[248:251], v255 offset:512
    s_waitcnt lgkmcnt(0)
    v_fma_f32 v236, -v253, v244, v248
    v_fmac_f32 v236, v160, v252
    v_max_f32 v236, 0, v236
    v_mul_f32 v236, v236, v236
    v_fma_f32 v237, -v253, v245, v249
    v_fmac_f32 v237, v161, v252
    v_max_f32 v237, 0, v237
    v_mul_f32 v237, v237, v237
    v_fma_f32 v238, -v253, v246, v250
    v_fmac_f32 v238, v162, v252
    v_max_f32 v238, 0, v238
    v_mul_f32 v238, v238, v238
    v_fma_f32 v239, -v253, v247, v251
    v_fmac_f32 v239, v163, v252
    v_max_f32 v239, 0, v239
    v_mul_f32 v239, v239, v239
    v_cvt_pk_bf16_f32 v240, v236, v237
    v_cvt_pk_bf16_f32 v241, v238, v239
    ds_read_b128 v[244:247], v255 offset:32
    ds_read_b128 v[248:251], v255 offset:544
    s_waitcnt lgkmcnt(0)
    v_fma_f32 v236, -v253, v244, v248
    v_fmac_f32 v236, v164, v252
    v_max_f32 v236, 0, v236
    v_mul_f32 v236, v236, v236
    v_fma_f32 v237, -v253, v245, v249
    v_fmac_f32 v237, v165, v252
    v_max_f32 v237, 0, v237
    v_mul_f32 v237, v237, v237
    v_fma_f32 v238, -v253, v246, v250
    v_fmac_f32 v238, v166, v252
    v_max_f32 v238, 0, v238
    v_mul_f32 v238, v238, v238
    v_fma_f32 v239, -v253, v247, v251
    v_fmac_f32 v239, v167, v252
    v_max_f32 v239, 0, v239
    v_mul_f32 v239, v239, v239
    v_cvt_pk_bf16_f32 v242, v236, v237
    v_cvt_pk_bf16_f32 v243, v238, v239
    s_nop 1
    v_permlane32_swap_b32 v240, v242
    v_permlane32_swap_b32 v241, v243
    buffer_store_dwordx4 v[240:243], v232, s[16:19], s61 offen offset:0
    ds_read_b128 v[244:247], v255 offset:64
    ds_read_b128 v[248:251], v255 offset:576
    s_waitcnt lgkmcnt(0)
    v_fma_f32 v236, -v253, v244, v248
    v_fmac_f32 v236, v168, v252
    v_max_f32 v236, 0, v236
    v_mul_f32 v236, v236, v236
    v_fma_f32 v237, -v253, v245, v249
    v_fmac_f32 v237, v169, v252
    v_max_f32 v237, 0, v237
    v_mul_f32 v237, v237, v237
    v_fma_f32 v238, -v253, v246, v250
    v_fmac_f32 v238, v170, v252
    v_max_f32 v238, 0, v238
    v_mul_f32 v238, v238, v238
    v_fma_f32 v239, -v253, v247, v251
    v_fmac_f32 v239, v171, v252
    v_max_f32 v239, 0, v239
    v_mul_f32 v239, v239, v239
    v_cvt_pk_bf16_f32 v240, v236, v237
    v_cvt_pk_bf16_f32 v241, v238, v239
    ds_read_b128 v[244:247], v255 offset:96
    ds_read_b128 v[248:251], v255 offset:608
    s_waitcnt lgkmcnt(0)
    v_fma_f32 v236, -v253, v244, v248
    v_fmac_f32 v236, v172, v252
    v_max_f32 v236, 0, v236
    v_mul_f32 v236, v236, v236
    v_fma_f32 v237, -v253, v245, v249
    v_fmac_f32 v237, v173, v252
    v_max_f32 v237, 0, v237
    v_mul_f32 v237, v237, v237
    v_fma_f32 v238, -v253, v246, v250
    v_fmac_f32 v238, v174, v252
    v_max_f32 v238, 0, v238
    v_mul_f32 v238, v238, v238
    v_fma_f32 v239, -v253, v247, v251
    v_fmac_f32 v239, v175, v252
    v_max_f32 v239, 0, v239
    v_mul_f32 v239, v239, v239
    v_cvt_pk_bf16_f32 v242, v236, v237
    v_cvt_pk_bf16_f32 v243, v238, v239
    s_nop 1
    v_permlane32_swap_b32 v240, v242
    v_permlane32_swap_b32 v241, v243
    buffer_store_dwordx4 v[240:243], v232, s[16:19], s61 offen offset:512
    v_add_u32 v254, 256, v254
    s_add_u32 s61, s61, s60
    s_mov_b32 s74, 81920
    v_add_u32 v224, s74, v224
    v_add_u32 v225, s74, v225
    v_add_u32 v226, s74, v226
    v_add_u32 v227, s74, v227
    v_add_u32 v228, s74, v228
    v_add_u32 v229, s74, v229
    v_add_u32 v230, s74, v230
    v_add_u32 v231, s74, v231
    s_mov_b32 s75, 4294885376
    s_mov_b32 s76, 40960
    s_mov_b32 s69, 2
    s_mov_b32 s70, 0
    s_waitcnt lgkmcnt(0)
    s_barrier
    ds_read_b128 v[192:195], v224 offset:0
    ds_read_b128 v[196:199], v225 offset:0
    ds_read_b128 v[200:203], v226 offset:0
    ds_read_b128 v[204:207], v227 offset:0
    ds_read_b128 v[208:211], v228 offset:0
    ds_read_b128 v[212:215], v229 offset:0
K1_LOOP_H:
    s_add_u32 s69, s69, 1
    s_cmp_ge_u32 s69, 3
    s_cselect_b32 s74, s75, s76
    s_cselect_b32 s69, 0, s69
    s_waitcnt lgkmcnt(5)
    v_mfma_f32_32x32x16_bf16 v[160:175], v[0:3], v[192:195], 0
    ds_read_b128 v[216:219], v230 offset:0
    s_waitcnt lgkmcnt(5)
    v_mfma_f32_32x32x16_bf16 v[160:175], v[4:7], v[196:199], v[160:175]
    ds_read_b128 v[220:223], v231 offset:0
    s_waitcnt lgkmcnt(5)
    v_mfma_f32_32x32x16_bf16 v[160:175], v[8:11], v[200:203], v[160:175]
    ds_read_b128 v[192:195], v224 offset:256
    ds_read2_b32 v[252:253], v254 offset0:0 offset1:32
    ds_read_b128 v[244:247], v255 offset:0
    ds_read_b128 v[248:251], v255 offset:512
    s_waitcnt lgkmcnt(8)
    v_mfma_f32_32x32x16_bf16 v[160:175], v[12:15], v[204:207], v[160:175]
    ds_read_b128 v[196:199], v225 offset:256
    s_waitcnt lgkmcnt(8)
    v_mfma_f32_32x32x16_bf16 v[160:175], v[16:19], v[208:211], v[160:175]
    ds_read_b128 v[200:203], v226 offset:256
    s_waitcnt lgkmcnt(8)
    v_mfma_f32_32x32x16_bf16 v[160:175], v[20:23], v[212:215], v[160:175]
    ds_read_b128 v[204:207], v227 offset:256
    s_waitcnt lgkmcnt(3)
    v_mfma_f32_32x32x16_bf16 v[160:175], v[24:27], v[216:219], v[160:175]
    ds_read_b128 v[208:211], v228 offset:256
    v_fma_f32 v236, -v253, v244, v248
    v_fmac_f32 v236, v176, v252
    v_max_f32 v236, 0, v236
    v_mul_f32 v236, v236, v236
    v_mfma_f32_32x32x16_bf16 v[160:175], v[28:31], v[220:223], v[160:175]
    ds_read_b128 v[212:215], v229 offset:256
    v_fma_f32 v237, -v253, v245, v249
    v_fmac_f32 v237, v177, v252
    v_max_f32 v237, 0, v237
    v_mul_f32 v237, v237, v237
    v_fma_f32 v238, -v253, v246, v250
    v_fmac_f32 v238, v178, v252
    v_max_f32 v238, 0, v238
    v_mul_f32 v238, v238, v238
    v_mfma_f32_32x32x16_bf16 v[160:175], v[32:35], v[192:195], v[160:175]
    ds_read_b128 v[216:219], v230 offset:256
    v_fma_f32 v239, -v253, v247, v251
    v_fmac_f32 v239, v179, v252
    v_max_f32 v239, 0, v239
    v_mul_f32 v239, v239, v239
    s_waitcnt lgkmcnt(5)
    v_mfma_f32_32x32x16_bf16 v[160:175], v[36:39], v[196:199], v[160:175]
    ds_read_b128 v[220:223], v231 offset:256
    v_cvt_pk_bf16_f32 v240, v236, v237
    v_cvt_pk_bf16_f32 v241, v238, v239
    s_waitcnt lgkmcnt(5)
    v_mfma_f32_32x32x16_bf16 v[160:175], v[40:43], v[200:203], v[160:175]
    ds_read_b128 v[192:195], v224 offset:512
    ds_read_b128 v[244:247], v255 offset:32
    ds_read_b128 v[248:251], v255 offset:544
    s_waitcnt lgkmcnt(7)
    v_mfma_f32_32x32x16_bf16 v[160:175], v[44:47], v[204:207], v[160:175]
    ds_read_b128 v[196:199], v225 offset:512
    s_waitcnt lgkmcnt(7)
    v_mfma_f32_32x32x16_bf16 v[160:175], v[48:51], v[208:211], v[160:175]
    ds_read_b128 v[200:203], v226 offset:512
    s_waitcnt lgkmcnt(2)
    v_mfma_f32_32x32x16_bf16 v[160:175], v[52:55], v[212:215], v[160:175]
    ds_read_b128 v[204:207], v227 offset:512
    v_fma_f32 v236, -v253, v244, v248
    v_fmac_f32 v236, v180, v252
    v_max_f32 v236, 0, v236
    v_mul_f32 v236, v236, v236
    v_mfma_f32_32x32x16_bf16 v[160:175], v[56:59], v[216:219], v[160:175]
    ds_read_b128 v[208:211], v228 offset:512
    v_fma_f32 v237, -v253, v245, v249
    v_fmac_f32 v237, v181, v252
    v_max_f32 v237, 0, v237
    v_mul_f32 v237, v237, v237
    v_mfma_f32_32x32x16_bf16 v[160:175], v[60:63], v[220:223], v[160:175]
    ds_read_b128 v[212:215], v229 offset:512
    v_fma_f32 v238, -v253, v246, v250
    v_fmac_f32 v238, v182, v252
    v_max_f32 v238, 0, v238
    v_mul_f32 v238, v238, v238
    v_mfma_f32_32x32x16_bf16 v[160:175], v[64:67], v[192:195], v[160:175]
    ds_read_b128 v[216:219], v230 offset:512
    v_fma_f32 v239, -v253, v247, v251
    v_fmac_f32 v239, v183, v252
    v_max_f32 v239, 0, v239
    v_mul_f32 v239, v239, v239
    s_waitcnt lgkmcnt(5)
    v_mfma_f32_32x32x16_bf16 v[160:175], v[68:71], v[196:199], v[160:175]
    ds_read_b128 v[220:223], v231 offset:512
    v_cvt_pk_bf16_f32 v242, v236, v237
    v_cvt_pk_bf16_f32 v243, v238, v239
    s_nop 1
    v_permlane32_swap_b32 v240, v242
    v_permlane32_swap_b32 v241, v243
    buffer_store_dwordx4 v[240:243], v232, s[16:19], s61 offen offset:0
    ds_read_b128 v[244:247], v255 offset:64
    ds_read_b128 v[248:251], v255 offset:576
    s_waitcnt lgkmcnt(7)
    v_mfma_f32_32x32x16_bf16 v[160:175], v[72:75], v[200:203], v[160:175]
    ds_read_b128 v[192:195], v224 offset:768
    s_waitcnt lgkmcnt(7)
    v_mfma_f32_32x32x16_bf16 v[160:175], v[76:79], v[204:207], v[160:175]
    ds_read_b128 v[196:199], v225 offset:768
    s_waitcnt lgkmcnt(7)
    v_mfma_f32_32x32x16_bf16 v[160:175], v[80:83], v[208:211], v[160:175]
    ds_read_b128 v[200:203], v226 offset:768
    s_waitcnt lgkmcnt(3)
    v_mfma_f32_32x32x16_bf16 v[160:175], v[84:87], v[212:215], v[160:175]
    ds_read_b128 v[204:207], v227 offset:768
    v_fma_f32 v236, -v253, v244, v248
    v_fmac_f32 v236, v184, v252
    v_max_f32 v236, 0, v236
    v_mul_f32 v236, v236, v236
    v_mfma_f32_32x32x16_bf16 v[160:175], v[88:91], v[216:219], v[160:175]
    ds_read_b128 v[208:211], v228 offset:768
    v_fma_f32 v237, -v253, v245, v249
    v_fmac_f32 v237, v185, v252
    v_max_f32 v237, 0, v237
    v_mul_f32 v237, v237, v237
    v_fma_f32 v238, -v253, v246, v250
    v_fmac_f32 v238, v186, v252
    v_max_f32 v238, 0, v238
    v_mul_f32 v238, v238, v238
    v_mfma_f32_32x32x16_bf16 v[160:175], v[92:95], v[220:223], v[160:175]
    ds_read_b128 v[212:215], v229 offset:768
    v_fma_f32 v239, -v253, v247, v251
    v_fmac_f32 v239, v187, v252
    v_max_f32 v239, 0, v239
    v_mul_f32 v239, v239, v239
    s_waitcnt lgkmcnt(5)
    v_mfma_f32_32x32x16_bf16 v[160:175], v[96:99], v[192:195], v[160:175]
    ds_read_b128 v[216:219], v230 offset:768
    v_cvt_pk_bf16_f32 v240, v236, v237
    v_cvt_pk_bf16_f32 v241, v238, v239
    s_waitcnt lgkmcnt(5)
    v_mfma_f32_32x32x16_bf16 v[160:175], v[100:103], v[196:199], v[160:175]
    ds_read_b128 v[220:223], v231 offset:768
    ds_read_b128 v[244:247], v255 offset:96
    ds_read_b128 v[248:251], v255 offset:608
    s_waitcnt lgkmcnt(7)
    v_mfma_f32_32x32x16_bf16 v[160:175], v[104:107], v[200:203], v[160:175]
    ds_read_b128 v[192:195], v224 offset:1024
    s_waitcnt lgkmcnt(7)
    v_mfma_f32_32x32x16_bf16 v[160:175], v[108:111], v[204:207], v[160:175]
    ds_read_b128 v[196:199], v225 offset:1024
    s_waitcnt lgkmcnt(2)
    v_mfma_f32_32x32x16_bf16 v[160:175], v[112:115], v[208:211], v[160:175]
    ds_read_b128 v[200:203], v226 offset:1024
    v_fma_f32 v236, -v253, v244, v248
    v_fmac_f32 v236, v188, v252
    v_max_f32 v236, 0, v236
    v_mul_f32 v236, v236, v236
    v_mfma_f32_32x32x16_bf16 v[160:175], v[116:119], v[212:215], v[160:175]
    ds_read_b128 v[204:207], v227 offset:1024
    v_fma_f32 v237, -v253, v245, v249
    v_fmac_f32 v237, v189, v252
    v_max_f32 v237, 0, v237
    v_mul_f32 v237, v237, v237
    v_mfma_f32_32x32x16_bf16 v[160:175], v[120:123], v[216:219], v[160:175]
    ds_read_b128 v[208:211], v228 offset:1024
    v_fma_f32 v238, -v253, v246, v250
    v_fmac_f32 v238, v190, v252
    v_max_f32 v238, 0, v238
    v_mul_f32 v238, v238, v238
    v_mfma_f32_32x32x16_bf16 v[160:175], v[124:127], v[220:223], v[160:175]
    ds_read_b128 v[212:215], v229 offset:1024
    v_fma_f32 v239, -v253, v247, v251
    v_fmac_f32 v239, v191, v252
    v_max_f32 v239, 0, v239
    v_mul_f32 v239, v239, v239
    s_waitcnt lgkmcnt(5)
    v_mfma_f32_32x32x16_bf16 v[160:175], v[128:131], v[192:195], v[160:175]
    ds_read_b128 v[216:219], v230 offset:1024
    v_cvt_pk_bf16_f32 v242, v236, v237
    v_cvt_pk_bf16_f32 v243, v238, v239
    s_nop 1
    v_permlane32_swap_b32 v240, v242
    v_permlane32_swap_b32 v241, v243
    buffer_store_dwordx4 v[240:243], v232, s[16:19], s61 offen offset:512
    s_waitcnt lgkmcnt(5)
    v_mfma_f32_32x32x16_bf16 v[160:175], v[132:135], v[196:199], v[160:175]
    ds_read_b128 v[220:223], v231 offset:1024
    s_waitcnt lgkmcnt(5)
    v_mfma_f32_32x32x16_bf16 v[160:175], v[136:139], v[200:203], v[160:175]
    s_waitcnt lgkmcnt(4)
    v_mfma_f32_32x32x16_bf16 v[160:175], v[140:143], v[204:207], v[160:175]
    s_waitcnt lgkmcnt(0)
    s_barrier
    v_add_u32 v224, s74, v224
    v_add_u32 v225, s74, v225
    v_add_u32 v226, s74, v226
    v_add_u32 v227, s74, v227
    v_add_u32 v228, s74, v228
    v_add_u32 v229, s74, v229
    v_add_u32 v230, s74, v230
    v_add_u32 v231, s74, v231
    ds_read_b128 v[192:195], v224 offset:0
    ds_read_b128 v[196:199], v225 offset:0
    v_mfma_f32_32x32x16_bf16 v[160:175], v[144:147], v[208:211], v[160:175]
    ds_read_b128 v[200:203], v226 offset:0
    v_mfma_f32_32x32x16_bf16 v[160:175], v[148:151], v[212:215], v[160:175]
    ds_read_b128 v[204:207], v227 offset:0
    v_mfma_f32_32x32x16_bf16 v[160:175], v[152:155], v[216:219], v[160:175]
    ds_read_b128 v[208:211], v228 offset:0
    v_mfma_f32_32x32x16_bf16 v[160:175], v[156:159], v[220:223], v[160:175]
    ds_read_b128 v[212:215], v229 offset:0
    s_add_u32 s61, s61, s60
    v_add_u32 v254, 256, v254
    s_add_u32 s69, s69, 1
    s_cmp_ge_u32 s69, 3
    s_cselect_b32 s74, s75, s76
    s_cselect_b32 s69, 0, s69
    s_waitcnt lgkmcnt(5)
    v_mfma_f32_32x32x16_bf16 v[176:191], v[0:3], v[192:195], 0
    ds_read_b128 v[216:219], v230 offset:0
    s_waitcnt lgkmcnt(5)
    v_mfma_f32_32x32x16_bf16 v[176:191], v[4:7], v[196:199], v[176:191]
    ds_read_b128 v[220:223], v231 offset:0
    s_waitcnt lgkmcnt(5)
    v_mfma_f32_32x32x16_bf16 v[176:191], v[8:11], v[200:203], v[176:191]
    ds_read_b128 v[192:195], v224 offset:256
    ds_read2_b32 v[252:253], v254 offset0:0 offset1:32
    ds_read_b128 v[244:247], v255 offset:0
    ds_read_b128 v[248:251], v255 offset:512
    s_waitcnt lgkmcnt(8)
    v_mfma_f32_32x32x16_bf16 v[176:191], v[12:15], v[204:207], v[176:191]
    ds_read_b128 v[196:199], v225 offset:256
    s_waitcnt lgkmcnt(8)
    v_mfma_f32_32x32x16_bf16 v[176:191], v[16:19], v[208:211], v[176:191]
    ds_read_b128 v[200:203], v226 offset:256
    s_waitcnt lgkmcnt(8)
    v_mfma_f32_32x32x16_bf16 v[176:191], v[20:23], v[212:215], v[176:191]
    ds_read_b128 v[204:207], v227 offset:256
    s_waitcnt lgkmcnt(3)
    v_mfma_f32_32x32x16_bf16 v[176:191], v[24:27], v[216:219], v[176:191]
    ds_read_b128 v[208:211], v228 offset:256
    v_fma_f32 v236, -v253, v244, v248
    v_fmac_f32 v236, v160, v252
    v_max_f32 v236, 0, v236
    v_mul_f32 v236, v236, v236
    v_mfma_f32_32x32x16_bf16 v[176:191], v[28:31], v[220:223], v[176:191]
    ds_read_b128 v[212:215], v229 offset:256
    v_fma_f32 v237, -v253, v245, v249
    v_fmac_f32 v237, v161, v252
    v_max_f32 v237, 0, v237
    v_mul_f32 v237, v237, v237
    v_fma_f32 v238, -v253, v246, v250
    v_fmac_f32 v238, v162, v252
    v_max_f32 v238, 0, v238
    v_mul_f32 v238, v238, v238
    v_mfma_f32_32x32x16_bf16 v[176:191], v[32:35], v[192:195], v[176:191]
    ds_read_b128 v[216:219], v230 offset:256
    v_fma_f32 v239, -v253, v247, v251
    v_fmac_f32 v239, v163, v252
    v_max_f32 v239, 0, v239
    v_mul_f32 v239, v239, v239
    s_waitcnt lgkmcnt(5)
    v_mfma_f32_32x32x16_bf16 v[176:191], v[36:39], v[196:199], v[176:191]
    ds_read_b128 v[220:223], v231 offset:256
    v_cvt_pk_bf16_f32 v240, v236, v237
    v_cvt_pk_bf16_f32 v241, v238, v239
    s_waitcnt lgkmcnt(5)
    v_mfma_f32_32x32x16_bf16 v[176:191], v[40:43], v[200:203], v[176:191]
    ds_read_b128 v[192:195], v224 offset:512
    ds_read_b128 v[244:247], v255 offset:32
    ds_read_b128 v[248:251], v255 offset:544
    s_waitcnt lgkmcnt(7)
    v_mfma_f32_32x32x16_bf16 v[176:191], v[44:47], v[204:207], v[176:191]
    ds_read_b128 v[196:199], v225 offset:512
    s_waitcnt lgkmcnt(7)
    v_mfma_f32_32x32x16_bf16 v[176:191], v[48:51], v[208:211], v[176:191]
    ds_read_b128 v[200:203], v226 offset:512
    s_waitcnt lgkmcnt(2)
    v_mfma_f32_32x32x16_bf16 v[176:191], v[52:55], v[212:215], v[176:191]
    ds_read_b128 v[204:207], v227 offset:512
    v_fma_f32 v236, -v253, v244, v248
    v_fmac_f32 v236, v164, v252
    v_max_f32 v236, 0, v236
    v_mul_f32 v236, v236, v236
    v_mfma_f32_32x32x16_bf16 v[176:191], v[56:59], v[216:219], v[176:191]
    ds_read_b128 v[208:211], v228 offset:512
    v_fma_f32 v237, -v253, v245, v249
    v_fmac_f32 v237, v165, v252
    v_max_f32 v237, 0, v237
    v_mul_f32 v237, v237, v237
    v_mfma_f32_32x32x16_bf16 v[176:191], v[60:63], v[220:223], v[176:191]
    ds_read_b128 v[212:215], v229 offset:512
    v_fma_f32 v238, -v253, v246, v250
    v_fmac_f32 v238, v166, v252
    v_max_f32 v238, 0, v238
    v_mul_f32 v238, v238, v238
    v_mfma_f32_32x32x16_bf16 v[176:191], v[64:67], v[192:195], v[176:191]
    ds_read_b128 v[216:219], v230 offset:512
    v_fma_f32 v239, -v253, v247, v251
    v_fmac_f32 v239, v167, v252
    v_max_f32 v239, 0, v239
    v_mul_f32 v239, v239, v239
    s_waitcnt lgkmcnt(5)
    v_mfma_f32_32x32x16_bf16 v[176:191], v[68:71], v[196:199], v[176:191]
    ds_read_b128 v[220:223], v231 offset:512
    v_cvt_pk_bf16_f32 v242, v236, v237
    v_cvt_pk_bf16_f32 v243, v238, v239
    s_nop 1
    v_permlane32_swap_b32 v240, v242
    v_permlane32_swap_b32 v241, v243
    buffer_store_dwordx4 v[240:243], v232, s[16:19], s61 offen offset:0
    ds_read_b128 v[244:247], v255 offset:64
    ds_read_b128 v[248:251], v255 offset:576
    s_waitcnt lgkmcnt(7)
    v_mfma_f32_32x32x16_bf16 v[176:191], v[72:75], v[200:203], v[176:191]
    ds_read_b128 v[192:195], v224 offset:768
    s_waitcnt lgkmcnt(7)
    v_mfma_f32_32x32x16_bf16 v[176:191], v[76:79], v[204:207], v[176:191]
    ds_read_b128 v[196:199], v225 offset:768
    s_waitcnt lgkmcnt(7)
    v_mfma_f32_32x32x16_bf16 v[176:191], v[80:83], v[208:211], v[176:191]
    ds_read_b128 v[200:203], v226 offset:768
    s_waitcnt lgkmcnt(3)
    v_mfma_f32_32x32x16_bf16 v[176:191], v[84:87], v[212:215], v[176:191]
    ds_read_b128 v[204:207], v227 offset:768
    v_fma_f32 v236, -v253, v244, v248
    v_fmac_f32 v236, v168, v252
    v_max_f32 v236, 0, v236
    v_mul_f32 v236, v236, v236
    v_mfma_f32_32x32x16_bf16 v[176:191], v[88:91], v[216:219], v[176:191]
    ds_read_b128 v[208:211], v228 offset:768
    v_fma_f32 v237, -v253, v245, v249
    v_fmac_f32 v237, v169, v252
    v_max_f32 v237, 0, v237
    v_mul_f32 v237, v237, v237
    v_fma_f32 v238, -v253, v246, v250
    v_fmac_f32 v238, v170, v252
    v_max_f32 v238, 0, v238
    v_mul_f32 v238, v238, v238
    v_mfma_f32_32x32x16_bf16 v[176:191], v[92:95], v[220:223], v[176:191]
    ds_read_b128 v[212:215], v229 offset:768
    v_fma_f32 v239, -v253, v247, v251
    v_fmac_f32 v239, v171, v252
    v_max_f32 v239, 0, v239
    v_mul_f32 v239, v239, v239
    s_waitcnt lgkmcnt(5)
    v_mfma_f32_32x32x16_bf16 v[176:191], v[96:99], v[192:195], v[176:191]
    ds_read_b128 v[216:219], v230 offset:768
    v_cvt_pk_bf16_f32 v240, v236, v237
    v_cvt_pk_bf16_f32 v241, v238, v239
    s_waitcnt lgkmcnt(5)
    v_mfma_f32_32x32x16_bf16 v[176:191], v[100:103], v[196:199], v[176:191]
    ds_read_b128 v[220:223], v231 offset:768
    ds_read_b128 v[244:247], v255 offset:96
    ds_read_b128 v[248:251], v255 offset:608
    s_waitcnt lgkmcnt(7)
    v_mfma_f32_32x32x16_bf16 v[176:191], v[104:107], v[200:203], v[176:191]
    ds_read_b128 v[192:195], v224 offset:1024
    s_waitcnt lgkmcnt(7)
    v_mfma_f32_32x32x16_bf16 v[176:191], v[108:111], v[204:207], v[176:191]
    ds_read_b128 v[196:199], v225 offset:1024
    s_waitcnt lgkmcnt(2)
    v_mfma_f32_32x32x16_bf16 v[176:191], v[112:115], v[208:211], v[176:191]
    ds_read_b128 v[200:203], v226 offset:1024
    v_fma_f32 v236, -v253, v244, v248
    v_fmac_f32 v236, v172, v252
    v_max_f32 v236, 0, v236
    v_mul_f32 v236, v236, v236
    v_mfma_f32_32x32x16_bf16 v[176:191], v[116:119], v[212:215], v[176:191]
    ds_read_b128 v[204:207], v227 offset:1024
    v_fma_f32 v237, -v253, v245, v249
    v_fmac_f32 v237, v173, v252
    v_max_f32 v237, 0, v237
    v_mul_f32 v237, v237, v237
    v_mfma_f32_32x32x16_bf16 v[176:191], v[120:123], v[216:219], v[176:191]
    ds_read_b128 v[208:211], v228 offset:1024
    v_fma_f32 v238, -v253, v246, v250
    v_fmac_f32 v238, v174, v252
    v_max_f32 v238, 0, v238
    v_mul_f32 v238, v238, v238
    v_mfma_f32_32x32x16_bf16 v[176:191], v[124:127], v[220:223], v[176:191]
    ds_read_b128 v[212:215], v229 offset:1024
    v_fma_f32 v239, -v253, v247, v251
    v_fmac_f32 v239, v175, v252
    v_max_f32 v239, 0, v239
    v_mul_f32 v239, v239, v239
    s_waitcnt lgkmcnt(5)
    v_mfma_f32_32x32x16_bf16 v[176:191], v[128:131], v[192:195], v[176:191]
    ds_read_b128 v[216:219], v230 offset:1024
    v_cvt_pk_bf16_f32 v242, v236, v237
    v_cvt_pk_bf16_f32 v243, v238, v239
    s_nop 1
    v_permlane32_swap_b32 v240, v242
    v_permlane32_swap_b32 v241, v243
    buffer_store_dwordx4 v[240:243], v232, s[16:19], s61 offen offset:512
    s_waitcnt lgkmcnt(5)
    v_mfma_f32_32x32x16_bf16 v[176:191], v[132:135], v[196:199], v[176:191]
    ds_read_b128 v[220:223], v231 offset:1024
    s_waitcnt lgkmcnt(5)
    v_mfma_f32_32x32x16_bf16 v[176:191], v[136:139], v[200:203], v[176:191]
    s_waitcnt lgkmcnt(4)
    v_mfma_f32_32x32x16_bf16 v[176:191], v[140:143], v[204:207], v[176:191]
    s_waitcnt lgkmcnt(0)
    s_cmp_eq_u32 s70, 2
    s_cbranch_scc1 K1_LOOP_H_nb
    s_barrier
K1_LOOP_H_nb:
    v_add_u32 v224, s74, v224
    v_add_u32 v225, s74, v225
    v_add_u32 v226, s74, v226
    v_add_u32 v227, s74, v227
    v_add_u32 v228, s74, v228
    v_add_u32 v229, s74, v229
    v_add_u32 v230, s74, v230
    v_add_u32 v231, s74, v231
    ds_read_b128 v[192:195], v224 offset:0
    ds_read_b128 v[196:199], v225 offset:0
    v_mfma_f32_32x32x16_bf16 v[176:191], v[144:147], v[208:211], v[176:191]
    ds_read_b128 v[200:203], v226 offset:0
    v_mfma_f32_32x32x16_bf16 v[176:191], v[148:151], v[212:215], v[176:191]
    ds_read_b128 v[204:207], v227 offset:0
    v_mfma_f32_32x32x16_bf16 v[176:191], v[152:155], v[216:219], v[176:191]
    ds_read_b128 v[208:211], v228 offset:0
    v_mfma_f32_32x32x16_bf16 v[176:191], v[156:159], v[220:223], v[176:191]
    ds_read_b128 v[212:215], v229 offset:0
    s_add_u32 s61, s61, s60
    v_add_u32 v254, 256, v254
    s_add_u32 s70, s70, 1
    s_cmp_lt_u32 s70, 3
    s_cbranch_scc1 K1_LOOP_H
    s_waitcnt lgkmcnt(0)
    s_nop 7
    s_nop 7
    ds_read2_b32 v[252:253], v254 offset0:0 offset1:32
    ds_read_b128 v[244:247], v255 offset:0
    ds_read_b128 v[248:251], v255 offset:512
    s_waitcnt lgkmcnt(0)
    v_fma_f32 v236, -v253, v244, v248
    v_fmac_f32 v236, v176, v252
    v_max_f32 v236, 0, v236
    v_mul_f32 v236, v236, v236
    v_fma_f32 v237, -v253, v245, v249
    v_fmac_f32 v237, v177, v252
    v_max_f32 v237, 0, v237
    v_mul_f32 v237, v237, v237
    v_fma_f32 v238, -v253, v246, v250
    v_fmac_f32 v238, v178, v252
    v_max_f32 v238, 0, v238
    v_mul_f32 v238, v238, v238
    v_fma_f32 v239, -v253, v247, v251
    v_fmac_f32 v239, v179, v252
    v_max_f32 v239, 0, v239
    v_mul_f32 v239, v239, v239
    v_cvt_pk_bf16_f32 v240, v236, v237
    v_cvt_pk_bf16_f32 v241, v238, v239
    ds_read_b128 v[244:247], v255 offset:32
    ds_read_b128 v[248:251], v255 offset:544
    s_waitcnt lgkmcnt(0)
    v_fma_f32 v236, -v253, v244, v248
    v_fmac_f32 v236, v180, v252
    v_max_f32 v236, 0, v236
    v_mul_f32 v236, v236, v236
    v_fma_f32 v237, -v253, v245, v249
    v_fmac_f32 v237, v181, v252
    v_max_f32 v237, 0, v237
    v_mul_f32 v237, v237, v237
    v_fma_f32 v238, -v253, v246, v250
    v_fmac_f32 v238, v182, v252
    v_max_f32 v238, 0, v238
    v_mul_f32 v238, v238, v238
    v_fma_f32 v239, -v253, v247, v251
    v_fmac_f32 v239, v183, v252
    v_max_f32 v239, 0, v239
    v_mul_f32 v239, v239, v239
    v_cvt_pk_bf16_f32 v242, v236, v237
    v_cvt_pk_bf16_f32 v243, v238, v239
    s_nop 1
    v_permlane32_swap_b32 v240, v242
    v_permlane32_swap_b32 v241, v243
    buffer_store_dwordx4 v[240:243], v232, s[16:19], s61 offen offset:0
    ds_read_b128 v[244:247], v255 offset:64
    ds_read_b128 v[248:251], v255 offset:576
    s_waitcnt lgkmcnt(0)
    v_fma_f32 v236, -v253, v244, v248
    v_fmac_f32 v236, v184, v252
    v_max_f32 v236, 0, v236
    v_mul_f32 v236, v236, v236
    v_fma_f32 v237, -v253, v245, v249
    v_fmac_f32 v237, v185, v252
    v_max_f32 v237, 0, v237
    v_mul_f32 v237, v237, v237
    v_fma_f32 v238, -v253, v246, v250
    v_fmac_f32 v238, v186, v252
    v_max_f32 v238, 0, v238
    v_mul_f32 v238, v238, v238
    v_fma_f32 v239, -v253, v247, v251
    v_fmac_f32 v239, v187, v252
    v_max_f32 v239, 0, v239
    v_mul_f32 v239, v239, v239
    v_cvt_pk_bf16_f32 v240, v236, v237
    v_cvt_pk_bf16_f32 v241, v238, v239
    ds_read_b128 v[244:247], v255 offset:96
    ds_read_b128 v[248:251], v255 offset:608
    s_waitcnt lgkmcnt(0)
    v_fma_f32 v236, -v253, v244, v248
    v_fmac_f32 v236, v188, v252
    v_max_f32 v236, 0, v236
    v_mul_f32 v236, v236, v236
    v_fma_f32 v237, -v253, v245, v249
    v_fmac_f32 v237, v189, v252
    v_max_f32 v237, 0, v237
    v_mul_f32 v237, v237, v237
    v_fma_f32 v238, -v253, v246, v250
    v_fmac_f32 v238, v190, v252
    v_max_f32 v238, 0, v238
    v_mul_f32 v238, v238, v238
    v_fma_f32 v239, -v253, v247, v251
    v_fmac_f32 v239, v191, v252
    v_max_f32 v239, 0, v239
    v_mul_f32 v239, v239, v239
    v_cvt_pk_bf16_f32 v242, v236, v237
    v_cvt_pk_bf16_f32 v243, v238, v239
    s_nop 1
    v_permlane32_swap_b32 v240, v242
    v_permlane32_swap_b32 v241, v243
    buffer_store_dwordx4 v[240:243], v232, s[16:19], s61 offen offset:512
    s_endpgm
K1_QK:
    v_and_b32 v10, 31, v243
    v_lshrrev_b32 v11, 5, v243
    s_cmp_lt_u32 s38, 5
    s_cselect_b32 s56, 0, 4194304
    s_cselect_b32 s57, 0, 5
    s_cselect_b32 s62, 0x3ea52b5c, 0x3f800000
    s_sub_u32 s57, s38, s57
    s_lshl_b32 s57, s57, 7
    s_lshl_b32 s58, s41, 5
    s_add_u32 s57, s57, s58
    v_mul_u32_u24 v12, 40, v10
    v_lshl_add_u32 v13, v11, 2, s57
    v_mul_u32_u24 v14, 3277, v13
    v_lshrrev_b32 v14, 16, v14
    v_mul_u32_u24 v14, 81880, v14
    v_lshl_add_u32 v14, v13, 1, v14
    v_add_u32 v232, v14, v12
    v_lshl_add_u32 v13, v11, 2, s57
    v_add_u32 v13, 8, v13
    v_mul_u32_u24 v14, 3277, v13
    v_lshrrev_b32 v14, 16, v14
    v_mul_u32_u24 v14, 81880, v14
    v_lshl_add_u32 v14, v13, 1, v14
    v_add_u32 v233, v14, v12
    v_lshl_add_u32 v13, v11, 2, s57
    v_add_u32 v13, 16, v13
    v_mul_u32_u24 v14, 3277, v13
    v_lshrrev_b32 v14, 16, v14
    v_mul_u32_u24 v14, 81880, v14
    v_lshl_add_u32 v14, v13, 1, v14
    v_add_u32 v234, v14, v12
    v_lshl_add_u32 v13, v11, 2, s57
    v_add_u32 v13, 24, v13
    v_mul_u32_u24 v14, 3277, v13
    v_lshrrev_b32 v14, 16, v14
    v_mul_u32_u24 v14, 81880, v14
    v_lshl_add_u32 v14, v13, 1, v14
    v_add_u32 v235, v14, v12
    s_mul_i32 s59, s39, 1280
    s_add_u32 s59, s59, s56
    s_movk_i32 s60, 1280
    v_lshlrev_b32 v254, 2, v10
    v_add_u32 v254, 155648, v254
    s_lshl_b32 s51, s41, 7
    s_add_u32 s51, s51, 157696
    v_lshlrev_b32 v255, 4, v11
    v_add_u32 v255, s51, v255
    v_lshlrev_b32 v252, 2, v10
    v_add_u32 v252, s51, v252
    s_waitcnt vmcnt(0)
    s_barrier
    ds_read_b64_tr_b16 v[0:1], v237 offset:0
    ds_read_b64_tr_b16 v[2:3], v237 offset:1024
    ds_read_b64_tr_b16 v[4:5], v237 offset:4096
    ds_read_b64_tr_b16 v[6:7], v237 offset:5120
    ds_read_b64_tr_b16 v[8:9], v237 offset:8192
    ds_read_b64_tr_b16 v[10:11], v237 offset:9216
    ds_read_b64_tr_b16 v[12:13], v237 offset:12288
    ds_read_b64_tr_b16 v[14:15], v237 offset:13312
    ds_read_b128 v[192:195], v224 offset:0
    ds_read_b128 v[196:199], v225 offset:0
    ds_read_b128 v[200:203], v226 offset:0
    ds_read_b128 v[204:207], v227 offset:0
    ds_read_b128 v[208:211], v224 offset:40960
    ds_read_b128 v[212:215], v225 offset:40960
    ds_read_b128 v[216:219], v226 offset:40960
    ds_read_b128 v[220:223], v227 offset:40960
    s_waitcnt lgkmcnt(8)
    s_barrier
    ds_read_b64_tr_b16 v[16:17], v237 offset:16384
    ds_read_b64_tr_b16 v[18:19], v237 offset:17408
    ds_read_b64_tr_b16 v[20:21], v237 offset:20480
    ds_read_b64_tr_b16 v[22:23], v237 offset:21504
    ds_read_b64_tr_b16 v[24:25], v237 offset:24576
    ds_read_b64_tr_b16 v[26:27], v237 offset:25600
    ds_read_b64_tr_b16 v[28:29], v237 offset:28672
    ds_read_b64_tr_b16 v[30:31], v237 offset:29696
    s_waitcnt lgkmcnt(8)
    v_dot2c_f32_bf16 v238, v239, v0
    v_dot2c_f32_bf16 v238, v239, v1
    v_dot2c_f32_bf16 v238, v239, v2
    v_dot2c_f32_bf16 v238, v239, v3
    v_dot2c_f32_bf16 v238, v239, v4
    v_dot2c_f32_bf16 v238, v239, v5
    v_dot2c_f32_bf16 v238, v239, v6
    v_dot2c_f32_bf16 v238, v239, v7
    v_dot2c_f32_bf16 v238, v239, v8
    v_dot2c_f32_bf16 v238, v239, v9
    v_dot2c_f32_bf16 v238, v239, v10
    v_dot2c_f32_bf16 v238, v239, v11
    v_dot2c_f32_bf16 v238, v239, v12
    v_dot2c_f32_bf16 v238, v239, v13
    v_dot2c_f32_bf16 v238, v239, v14
    v_dot2c_f32_bf16 v238, v239, v15
    v_mfma_f32_32x32x16_bf16 v[160:175], v[0:3], v[192:195], 0
    ds_read_b128 v[192:195], v228 offset:0
    v_mfma_f32_32x32x16_bf16 v[176:191], v[0:3], v[208:211], 0
    ds_read_b128 v[208:211], v228 offset:40960
    v_mfma_f32_32x32x16_bf16 v[160:175], v[4:7], v[196:199], v[160:175]
    ds_read_b128 v[196:199], v229 offset:0
    v_mfma_f32_32x32x16_bf16 v[176:191], v[4:7], v[212:215], v[176:191]
    ds_read_b128 v[212:215], v229 offset:40960
    v_mfma_f32_32x32x16_bf16 v[160:175], v[8:11], v[200:203], v[160:175]
    ds_read_b128 v[200:203], v230 offset:0
    v_mfma_f32_32x32x16_bf16 v[176:191], v[8:11], v[216:219], v[176:191]
    ds_read_b128 v[216:219], v230 offset:40960
    v_mfma_f32_32x32x16_bf16 v[160:175], v[12:15], v[204:207], v[160:175]
    ds_read_b128 v[204:207], v231 offset:0
    v_mfma_f32_32x32x16_bf16 v[176:191], v[12:15], v[220:223], v[176:191]
    ds_read_b128 v[220:223], v231 offset:40960
    s_waitcnt lgkmcnt(8)
    s_barrier
    ds_read_b64_tr_b16 v[32:33], v236 offset:0
    ds_read_b64_tr_b16 v[34:35], v236 offset:1024
    ds_read_b64_tr_b16 v[36:37], v236 offset:4096
    ds_read_b64_tr_b16 v[38:39], v236 offset:5120
    ds_read_b64_tr_b16 v[40:41], v236 offset:8192
    ds_read_b64_tr_b16 v[42:43], v236 offset:9216
    ds_read_b64_tr_b16 v[44:45], v236 offset:12288
    ds_read_b64_tr_b16 v[46:47], v236 offset:13312
    s_waitcnt lgkmcnt(8)
    v_dot2c_f32_bf16 v238, v239, v16
    v_dot2c_f32_bf16 v238, v239, v17
    v_dot2c_f32_bf16 v238, v239, v18
    v_dot2c_f32_bf16 v238, v239, v19
    v_dot2c_f32_bf16 v238, v239, v20
    v_dot2c_f32_bf16 v238, v239, v21
    v_dot2c_f32_bf16 v238, v239, v22
    v_dot2c_f32_bf16 v238, v239, v23
    v_dot2c_f32_bf16 v238, v239, v24
    v_dot2c_f32_bf16 v238, v239, v25
    v_dot2c_f32_bf16 v238, v239, v26
    v_dot2c_f32_bf16 v238, v239, v27
    v_dot2c_f32_bf16 v238, v239, v28
    v_dot2c_f32_bf16 v238, v239, v29
    v_dot2c_f32_bf16 v238, v239, v30
    v_dot2c_f32_bf16 v238, v239, v31
    v_mfma_f32_32x32x16_bf16 v[160:175], v[16:19], v[192:195], v[160:175]
    ds_read_b128 v[192:195], v224 offset:256
    v_mfma_f32_32x32x16_bf16 v[176:191], v[16:19], v[208:211], v[176:191]
    ds_read_b128 v[208:211], v224 offset:41216
    v_mfma_f32_32x32x16_bf16 v[160:175], v[20:23], v[196:199], v[160:175]
    ds_read_b128 v[196:199], v225 offset:256
    v_mfma_f32_32x32x16_bf16 v[176:191], v[20:23], v[212:215], v[176:191]
    ds_read_b128 v[212:215], v225 offset:41216
    v_mfma_f32_32x32x16_bf16 v[160:175], v[24:27], v[200:203], v[160:175]
    ds_read_b128 v[200:203], v226 offset:256
    v_mfma_f32_32x32x16_bf16 v[176:191], v[24:27], v[216:219], v[176:191]
    ds_read_b128 v[216:219], v226 offset:41216
    v_mfma_f32_32x32x16_bf16 v[160:175], v[28:31], v[204:207], v[160:175]
    ds_read_b128 v[204:207], v227 offset:256
    v_mfma_f32_32x32x16_bf16 v[176:191], v[28:31], v[220:223], v[176:191]
    ds_read_b128 v[220:223], v227 offset:41216
    s_waitcnt lgkmcnt(8)
    s_barrier
    ds_read_b64_tr_b16 v[48:49], v236 offset:16384
    ds_read_b64_tr_b16 v[50:51], v236 offset:17408
    ds_read_b64_tr_b16 v[52:53], v236 offset:20480
    ds_read_b64_tr_b16 v[54:55], v236 offset:21504
    ds_read_b64_tr_b16 v[56:57], v236 offset:24576
    ds_read_b64_tr_b16 v[58:59], v236 offset:25600
    ds_read_b64_tr_b16 v[60:61], v236 offset:28672
    ds_read_b64_tr_b16 v[62:63], v236 offset:29696
    s_waitcnt lgkmcnt(8)
    v_dot2c_f32_bf16 v238, v239, v32
    v_dot2c_f32_bf16 v238, v239, v33
    v_dot2c_f32_bf16 v238, v239, v34
    v_dot2c_f32_bf16 v238, v239, v35
    v_dot2c_f32_bf16 v238, v239, v36
    v_dot2c_f32_bf16 v238, v239, v37
    v_dot2c_f32_bf16 v238, v239, v38
    v_dot2c_f32_bf16 v238, v239, v39
    v_dot2c_f32_bf16 v238, v239, v40
    v_dot2c_f32_bf16 v238, v239, v41
    v_dot2c_f32_bf16 v238, v239, v42
    v_dot2c_f32_bf16 v238, v239, v43
    v_dot2c_f32_bf16 v238, v239, v44
    v_dot2c_f32_bf16 v238, v239, v45
    v_dot2c_f32_bf16 v238, v239, v46
    v_dot2c_f32_bf16 v238, v239, v47
    v_mfma_f32_32x32x16_bf16 v[160:175], v[32:35], v[192:195], v[160:175]
    ds_read_b128 v[192:195], v228 offset:256
    v_mfma_f32_32x32x16_bf16 v[176:191], v[32:35], v[208:211], v[176:191]
    ds_read_b128 v[208:211], v228 offset:41216
    v_mfma_f32_32x32x16_bf16 v[160:175], v[36:39], v[196:199], v[160:175]
    ds_read_b128 v[196:199], v229 offset:256
    v_mfma_f32_32x32x16_bf16 v[176:191], v[36:39], v[212:215], v[176:191]
    ds_read_b128 v[212:215], v229 offset:41216
    v_mfma_f32_32x32x16_bf16 v[160:175], v[40:43], v[200:203], v[160:175]
    ds_read_b128 v[200:203], v230 offset:256
    v_mfma_f32_32x32x16_bf16 v[176:191], v[40:43], v[216:219], v[176:191]
    ds_read_b128 v[216:219], v230 offset:41216
    v_mfma_f32_32x32x16_bf16 v[160:175], v[44:47], v[204:207], v[160:175]
    ds_read_b128 v[204:207], v231 offset:256
    v_mfma_f32_32x32x16_bf16 v[176:191], v[44:47], v[220:223], v[176:191]
    ds_read_b128 v[220:223], v231 offset:41216
    s_waitcnt lgkmcnt(8)
    s_barrier
    ds_read_b64_tr_b16 v[64:65], v237 offset:0
    ds_read_b64_tr_b16 v[66:67], v237 offset:1024
    ds_read_b64_tr_b16 v[68:69], v237 offset:4096
    ds_read_b64_tr_b16 v[70:71], v237 offset:5120
    ds_read_b64_tr_b16 v[72:73], v237 offset:8192
    ds_read_b64_tr_b16 v[74:75], v237 offset:9216
    ds_read_b64_tr_b16 v[76:77], v237 offset:12288
    ds_read_b64_tr_b16 v[78:79], v237 offset:13312
    s_waitcnt lgkmcnt(8)
    v_dot2c_f32_bf16 v238, v239, v48
    v_dot2c_f32_bf16 v238, v239, v49
    v_dot2c_f32_bf16 v238, v239, v50
    v_dot2c_f32_bf16 v238, v239, v51
    v_dot2c_f32_bf16 v238, v239, v52
    v_dot2c_f32_bf16 v238, v239, v53
    v_dot2c_f32_bf16 v238, v239, v54
    v_dot2c_f32_bf16 v238, v239, v55
    v_dot2c_f32_bf16 v238, v239, v56
    v_dot2c_f32_bf16 v238, v239, v57
    v_dot2c_f32_bf16 v238, v239, v58
    v_dot2c_f32_bf16 v238, v239, v59
    v_dot2c_f32_bf16 v238, v239, v60
    v_dot2c_f32_bf16 v238, v239, v61
    v_dot2c_f32_bf16 v238, v239, v62
    v_dot2c_f32_bf16 v238, v239, v63
    v_mfma_f32_32x32x16_bf16 v[160:175], v[48:51], v[192:195], v[160:175]
    ds_read_b128 v[192:195], v224 offset:512
    v_mfma_f32_32x32x16_bf16 v[176:191], v[48:51], v[208:211], v[176:191]
    ds_read_b128 v[208:211], v224 offset:41472
    v_mfma_f32_32x32x16_bf16 v[160:175], v[52:55], v[196:199], v[160:175]
    ds_read_b128 v[196:199], v225 offset:512
    v_mfma_f32_32x32x16_bf16 v[176:191], v[52:55], v[212:215], v[176:191]
    ds_read_b128 v[212:215], v225 offset:41472
    v_mfma_f32_32x32x16_bf16 v[160:175], v[56:59], v[200:203], v[160:175]
    ds_read_b128 v[200:203], v226 offset:512
    v_mfma_f32_32x32x16_bf16 v[176:191], v[56:59], v[216:219], v[176:191]
    ds_read_b128 v[216:219], v226 offset:41472
    v_mfma_f32_32x32x16_bf16 v[160:175], v[60:63], v[204:207], v[160:175]
    ds_read_b128 v[204:207], v227 offset:512
    v_mfma_f32_32x32x16_bf16 v[176:191], v[60:63], v[220:223], v[176:191]
    ds_read_b128 v[220:223], v227 offset:41472
    s_waitcnt lgkmcnt(8)
    s_barrier
    ds_read_b64_tr_b16 v[80:81], v237 offset:16384
    ds_read_b64_tr_b16 v[82:83], v237 offset:17408
    ds_read_b64_tr_b16 v[84:85], v237 offset:20480
    ds_read_b64_tr_b16 v[86:87], v237 offset:21504
    ds_read_b64_tr_b16 v[88:89], v237 offset:24576
    ds_read_b64_tr_b16 v[90:91], v237 offset:25600
    ds_read_b64_tr_b16 v[92:93], v237 offset:28672
    ds_read_b64_tr_b16 v[94:95], v237 offset:29696
    s_waitcnt lgkmcnt(8)
    v_dot2c_f32_bf16 v238, v239, v64
    v_dot2c_f32_bf16 v238, v239, v65
    v_dot2c_f32_bf16 v238, v239, v66
    v_dot2c_f32_bf16 v238, v239, v67
    v_dot2c_f32_bf16 v238, v239, v68
    v_dot2c_f32_bf16 v238, v239, v69
    v_dot2c_f32_bf16 v238, v239, v70
    v_dot2c_f32_bf16 v238, v239, v71
    v_dot2c_f32_bf16 v238, v239, v72
    v_dot2c_f32_bf16 v238, v239, v73
    v_dot2c_f32_bf16 v238, v239, v74
    v_dot2c_f32_bf16 v238, v239, v75
    v_dot2c_f32_bf16 v238, v239, v76
    v_dot2c_f32_bf16 v238, v239, v77
    v_dot2c_f32_bf16 v238, v239, v78
    v_dot2c_f32_bf16 v238, v239, v79
    v_mfma_f32_32x32x16_bf16 v[160:175], v[64:67], v[192:195], v[160:175]
    ds_read_b128 v[192:195], v228 offset:512
    v_mfma_f32_32x32x16_bf16 v[176:191], v[64:67], v[208:211], v[176:191]
    ds_read_b128 v[208:211], v228 offset:41472
    v_mfma_f32_32x32x16_bf16 v[160:175], v[68:71], v[196:199], v[160:175]
    ds_read_b128 v[196:199], v229 offset:512
    v_mfma_f32_32x32x16_bf16 v[176:191], v[68:71], v[212:215], v[176:191]
    ds_read_b128 v[212:215], v229 offset:41472
    v_mfma_f32_32x32x16_bf16 v[160:175], v[72:75], v[200:203], v[160:175]
    ds_read_b128 v[200:203], v230 offset:512
    v_mfma_f32_32x32x16_bf16 v[176:191], v[72:75], v[216:219], v[176:191]
    ds_read_b128 v[216:219], v230 offset:41472
    v_mfma_f32_32x32x16_bf16 v[160:175], v[76:79], v[204:207], v[160:175]
    ds_read_b128 v[204:207], v231 offset:512
    v_mfma_f32_32x32x16_bf16 v[176:191], v[76:79], v[220:223], v[176:191]
    ds_read_b128 v[220:223], v231 offset:41472
    s_waitcnt lgkmcnt(8)
    s_barrier
    ds_read_b64_tr_b16 v[96:97], v236 offset:0
    ds_read_b64_tr_b16 v[98:99], v236 offset:1024
    ds_read_b64_tr_b16 v[100:101], v236 offset:4096
    ds_read_b64_tr_b16 v[102:103], v236 offset:5120
    ds_read_b64_tr_b16 v[104:105], v236 offset:8192
    ds_read_b64_tr_b16 v[106:107], v236 offset:9216
    ds_read_b64_tr_b16 v[108:109], v236 offset:12288
    ds_read_b64_tr_b16 v[110:111], v236 offset:13312
    s_waitcnt lgkmcnt(8)
    v_dot2c_f32_bf16 v238, v239, v80
    v_dot2c_f32_bf16 v238, v239, v81
    v_dot2c_f32_bf16 v238, v239, v82
    v_dot2c_f32_bf16 v238, v239, v83
    v_dot2c_f32_bf16 v238, v239, v84
    v_dot2c_f32_bf16 v238, v239, v85
    v_dot2c_f32_bf16 v238, v239, v86
    v_dot2c_f32_bf16 v238, v239, v87
    v_dot2c_f32_bf16 v238, v239, v88
    v_dot2c_f32_bf16 v238, v239, v89
    v_dot2c_f32_bf16 v238, v239, v90
    v_dot2c_f32_bf16 v238, v239, v91
    v_dot2c_f32_bf16 v238, v239, v92
    v_dot2c_f32_bf16 v238, v239, v93
    v_dot2c_f32_bf16 v238, v239, v94
    v_dot2c_f32_bf16 v238, v239, v95
    v_mfma_f32_32x32x16_bf16 v[160:175], v[80:83], v[192:195], v[160:175]
    ds_read_b128 v[192:195], v224 offset:768
    v_mfma_f32_32x32x16_bf16 v[176:191], v[80:83], v[208:211], v[176:191]
    ds_read_b128 v[208:211], v224 offset:41728
    v_mfma_f32_32x32x16_bf16 v[160:175], v[84:87], v[196:199], v[160:175]
    ds_read_b128 v[196:199], v225 offset:768
    v_mfma_f32_32x32x16_bf16 v[176:191], v[84:87], v[212:215], v[176:191]
    ds_read_b128 v[212:215], v225 offset:41728
    v_mfma_f32_32x32x16_bf16 v[160:175], v[88:91], v[200:203], v[160:175]
    ds_read_b128 v[200:203], v226 offset:768
    v_mfma_f32_32x32x16_bf16 v[176:191], v[88:91], v[216:219], v[176:191]
    ds_read_b128 v[216:219], v226 offset:41728
    v_mfma_f32_32x32x16_bf16 v[160:175], v[92:95], v[204:207], v[160:175]
    ds_read_b128 v[204:207], v227 offset:768
    v_mfma_f32_32x32x16_bf16 v[176:191], v[92:95], v[220:223], v[176:191]
    ds_read_b128 v[220:223], v227 offset:41728
    s_waitcnt lgkmcnt(8)
    s_barrier
    ds_read_b64_tr_b16 v[112:113], v236 offset:16384
    ds_read_b64_tr_b16 v[114:115], v236 offset:17408
    ds_read_b64_tr_b16 v[116:117], v236 offset:20480
    ds_read_b64_tr_b16 v[118:119], v236 offset:21504
    ds_read_b64_tr_b16 v[120:121], v236 offset:24576
    ds_read_b64_tr_b16 v[122:123], v236 offset:25600
    ds_read_b64_tr_b16 v[124:125], v236 offset:28672
    ds_read_b64_tr_b16 v[126:127], v236 offset:29696
    s_waitcnt lgkmcnt(8)
    v_dot2c_f32_bf16 v238, v239, v96
    v_dot2c_f32_bf16 v238, v239, v97
    v_dot2c_f32_bf16 v238, v239, v98
    v_dot2c_f32_bf16 v238, v239, v99
    v_dot2c_f32_bf16 v238, v239, v100
    v_dot2c_f32_bf16 v238, v239, v101
    v_dot2c_f32_bf16 v238, v239, v102
    v_dot2c_f32_bf16 v238, v239, v103
    v_dot2c_f32_bf16 v238, v239, v104
    v_dot2c_f32_bf16 v238, v239, v105
    v_dot2c_f32_bf16 v238, v239, v106
    v_dot2c_f32_bf16 v238, v239, v107
    v_dot2c_f32_bf16 v238, v239, v108
    v_dot2c_f32_bf16 v238, v239, v109
    v_dot2c_f32_bf16 v238, v239, v110
    v_dot2c_f32_bf16 v238, v239, v111
    v_mfma_f32_32x32x16_bf16 v[160:175], v[96:99], v[192:195], v[160:175]
    ds_read_b128 v[192:195], v228 offset:768
    v_mfma_f32_32x32x16_bf16 v[176:191], v[96:99], v[208:211], v[176:191]
    ds_read_b128 v[208:211], v228 offset:41728
    v_mfma_f32_32x32x16_bf16 v[160:175], v[100:103], v[196:199], v[160:175]
    ds_read_b128 v[196:199], v229 offset:768
    v_mfma_f32_32x32x16_bf16 v[176:191], v[100:103], v[212:215], v[176:191]
    ds_read_b128 v[212:215], v229 offset:41728
    v_mfma_f32_32x32x16_bf16 v[160:175], v[104:107], v[200:203], v[160:175]
    ds_read_b128 v[200:203], v230 offset:768
    v_mfma_f32_32x32x16_bf16 v[176:191], v[104:107], v[216:219], v[176:191]
    ds_read_b128 v[216:219], v230 offset:41728
    v_mfma_f32_32x32x16_bf16 v[160:175], v[108:111], v[204:207], v[160:175]
    ds_read_b128 v[204:207], v231 offset:768
    v_mfma_f32_32x32x16_bf16 v[176:191], v[108:111], v[220:223], v[176:191]
    ds_read_b128 v[220:223], v231 offset:41728
    s_waitcnt lgkmcnt(8)
    s_barrier
    ds_read_b64_tr_b16 v[128:129], v237 offset:0
    ds_read_b64_tr_b16 v[130:131], v237 offset:1024
    ds_read_b64_tr_b16 v[132:133], v237 offset:4096
    ds_read_b64_tr_b16 v[134:135], v237 offset:5120
    ds_read_b64_tr_b16 v[136:137], v237 offset:8192
    ds_read_b64_tr_b16 v[138:139], v237 offset:9216
    ds_read_b64_tr_b16 v[140:141], v237 offset:12288
    ds_read_b64_tr_b16 v[142:143], v237 offset:13312
    s_waitcnt lgkmcnt(8)
    v_dot2c_f32_bf16 v238, v239, v112
    v_dot2c_f32_bf16 v238, v239, v113
    v_dot2c_f32_bf16 v238, v239, v114
    v_dot2c_f32_bf16 v238, v239, v115
    v_dot2c_f32_bf16 v238, v239, v116
    v_dot2c_f32_bf16 v238, v239, v117
    v_dot2c_f32_bf16 v238, v239, v118
    v_dot2c_f32_bf16 v238, v239, v119
    v_dot2c_f32_bf16 v238, v239, v120
    v_dot2c_f32_bf16 v238, v239, v121
    v_dot2c_f32_bf16 v238, v239, v122
    v_dot2c_f32_bf16 v238, v239, v123
    v_dot2c_f32_bf16 v238, v239, v124
    v_dot2c_f32_bf16 v238, v239, v125
    v_dot2c_f32_bf16 v238, v239, v126
    v_dot2c_f32_bf16 v238, v239, v127
    v_mfma_f32_32x32x16_bf16 v[160:175], v[112:115], v[192:195], v[160:175]
    ds_read_b128 v[192:195], v224 offset:1024
    v_mfma_f32_32x32x16_bf16 v[176:191], v[112:115], v[208:211], v[176:191]
    ds_read_b128 v[208:211], v224 offset:41984
    v_mfma_f32_32x32x16_bf16 v[160:175], v[116:119], v[196:199], v[160:175]
    ds_read_b128 v[196:199], v225 offset:1024
    v_mfma_f32_32x32x16_bf16 v[176:191], v[116:119], v[212:215], v[176:191]
    ds_read_b128 v[212:215], v225 offset:41984
    v_mfma_f32_32x32x16_bf16 v[160:175], v[120:123], v[200:203], v[160:175]
    ds_read_b128 v[200:203], v226 offset:1024
    v_mfma_f32_32x32x16_bf16 v[176:191], v[120:123], v[216:219], v[176:191]
    ds_read_b128 v[216:219], v226 offset:41984
    v_mfma_f32_32x32x16_bf16 v[160:175], v[124:127], v[204:207], v[160:175]
    ds_read_b128 v[204:207], v227 offset:1024
    v_mfma_f32_32x32x16_bf16 v[176:191], v[124:127], v[220:223], v[176:191]
    ds_read_b128 v[220:223], v227 offset:41984
    s_waitcnt lgkmcnt(8)
    s_barrier
    ds_read_b64_tr_b16 v[144:145], v237 offset:16384
    ds_read_b64_tr_b16 v[146:147], v237 offset:17408
    ds_read_b64_tr_b16 v[148:149], v237 offset:20480
    ds_read_b64_tr_b16 v[150:151], v237 offset:21504
    ds_read_b64_tr_b16 v[152:153], v237 offset:24576
    ds_read_b64_tr_b16 v[154:155], v237 offset:25600
    ds_read_b64_tr_b16 v[156:157], v237 offset:28672
    ds_read_b64_tr_b16 v[158:159], v237 offset:29696
    s_waitcnt lgkmcnt(8)
    v_dot2c_f32_bf16 v238, v239, v128
    v_dot2c_f32_bf16 v238, v239, v129
    v_dot2c_f32_bf16 v238, v239, v130
    v_dot2c_f32_bf16 v238, v239, v131
    v_dot2c_f32_bf16 v238, v239, v132
    v_dot2c_f32_bf16 v238, v239, v133
    v_dot2c_f32_bf16 v238, v239, v134
    v_dot2c_f32_bf16 v238, v239, v135
    v_dot2c_f32_bf16 v238, v239, v136
    v_dot2c_f32_bf16 v238, v239, v137
    v_dot2c_f32_bf16 v238, v239, v138
    v_dot2c_f32_bf16 v238, v239, v139
    v_dot2c_f32_bf16 v238, v239, v140
    v_dot2c_f32_bf16 v238, v239, v141
    v_dot2c_f32_bf16 v238, v239, v142
    v_dot2c_f32_bf16 v238, v239, v143
    v_mfma_f32_32x32x16_bf16 v[160:175], v[128:131], v[192:195], v[160:175]
    ds_read_b128 v[192:195], v228 offset:1024
    v_mfma_f32_32x32x16_bf16 v[176:191], v[128:131], v[208:211], v[176:191]
    ds_read_b128 v[208:211], v228 offset:41984
    v_mfma_f32_32x32x16_bf16 v[160:175], v[132:135], v[196:199], v[160:175]
    ds_read_b128 v[196:199], v229 offset:1024
    v_mfma_f32_32x32x16_bf16 v[176:191], v[132:135], v[212:215], v[176:191]
    ds_read_b128 v[212:215], v229 offset:41984
    v_mfma_f32_32x32x16_bf16 v[160:175], v[136:139], v[200:203], v[160:175]
    ds_read_b128 v[200:203], v230 offset:1024
    v_mfma_f32_32x32x16_bf16 v[176:191], v[136:139], v[216:219], v[176:191]
    ds_read_b128 v[216:219], v230 offset:41984
    v_mfma_f32_32x32x16_bf16 v[160:175], v[140:143], v[204:207], v[160:175]
    ds_read_b128 v[204:207], v231 offset:1024
    v_mfma_f32_32x32x16_bf16 v[176:191], v[140:143], v[220:223], v[176:191]
    ds_read_b128 v[220:223], v231 offset:41984
    s_waitcnt lgkmcnt(8)
    s_waitcnt lgkmcnt(0)
    v_dot2c_f32_bf16 v238, v239, v144
    v_dot2c_f32_bf16 v238, v239, v145
    v_dot2c_f32_bf16 v238, v239, v146
    v_dot2c_f32_bf16 v238, v239, v147
    v_dot2c_f32_bf16 v238, v239, v148
    v_dot2c_f32_bf16 v238, v239, v149
    v_dot2c_f32_bf16 v238, v239, v150
    v_dot2c_f32_bf16 v238, v239, v151
    v_dot2c_f32_bf16 v238, v239, v152
    v_dot2c_f32_bf16 v238, v239, v153
    v_dot2c_f32_bf16 v238, v239, v154
    v_dot2c_f32_bf16 v238, v239, v155
    v_dot2c_f32_bf16 v238, v239, v156
    v_dot2c_f32_bf16 v238, v239, v157
    v_dot2c_f32_bf16 v238, v239, v158
    v_dot2c_f32_bf16 v238, v239, v159
    v_mfma_f32_32x32x16_bf16 v[160:175], v[144:147], v[192:195], v[160:175]
    v_mfma_f32_32x32x16_bf16 v[176:191], v[144:147], v[208:211], v[176:191]
    v_mfma_f32_32x32x16_bf16 v[160:175], v[148:151], v[196:199], v[160:175]
    v_mfma_f32_32x32x16_bf16 v[176:191], v[148:151], v[212:215], v[176:191]
    v_mfma_f32_32x32x16_bf16 v[160:175], v[152:155], v[200:203], v[160:175]
    v_mfma_f32_32x32x16_bf16 v[176:191], v[152:155], v[216:219], v[176:191]
    v_mfma_f32_32x32x16_bf16 v[160:175], v[156:159], v[204:207], v[160:175]
    v_mfma_f32_32x32x16_bf16 v[176:191], v[156:159], v[220:223], v[176:191]
    s_waitcnt lgkmcnt(0)
    s_barrier
    s_nop 2
    v_mov_b32 v240, v238
    s_nop 1
    v_permlane32_swap_b32 v238, v240
    s_nop 1
    v_add_f32 v238, v238, v240
    ds_write_b32 v252, v238
    s_waitcnt lgkmcnt(0)
    s_mov_b32 s61, s59
    s_nop 7
    s_nop 7
    ds_read2_b32 v[252:253], v254 offset0:0 offset1:32
    ds_read_b128 v[244:247], v255 offset:0
    s_waitcnt lgkmcnt(0)
    v_mul_f32 v252, s62, v252
    v_mul_f32 v253, s62, v253
    v_mul_f32 v236, v253, v244
    v_fma_f32 v236, v160, v252, -v236
    v_mul_f32 v237, v253, v245
    v_fma_f32 v237, v161, v252, -v237
    v_mul_f32 v238, v253, v246
    v_fma_f32 v238, v162, v252, -v238
    v_mul_f32 v239, v253, v247
    v_fma_f32 v239, v163, v252, -v239
    v_cvt_pk_bf16_f32 v240, v236, v237
    v_cvt_pk_bf16_f32 v241, v238, v239
    buffer_store_dwordx2 v[240:241], v232, s[16:19], s61 offen
    ds_read_b128 v[244:247], v255 offset:32
    s_waitcnt lgkmcnt(0)
    v_mul_f32 v236, v253, v244
    v_fma_f32 v236, v164, v252, -v236
    v_mul_f32 v237, v253, v245
    v_fma_f32 v237, v165, v252, -v237
    v_mul_f32 v238, v253, v246
    v_fma_f32 v238, v166, v252, -v238
    v_mul_f32 v239, v253, v247
    v_fma_f32 v239, v167, v252, -v239
    v_cvt_pk_bf16_f32 v242, v236, v237
    v_cvt_pk_bf16_f32 v243, v238, v239
    buffer_store_dwordx2 v[242:243], v233, s[16:19], s61 offen
    ds_read_b128 v[244:247], v255 offset:64
    s_waitcnt lgkmcnt(0)
    v_mul_f32 v236, v253, v244
    v_fma_f32 v236, v168, v252, -v236
    v_mul_f32 v237, v253, v245
    v_fma_f32 v237, v169, v252, -v237
    v_mul_f32 v238, v253, v246
    v_fma_f32 v238, v170, v252, -v238
    v_mul_f32 v239, v253, v247
    v_fma_f32 v239, v171, v252, -v239
    v_cvt_pk_bf16_f32 v240, v236, v237
    v_cvt_pk_bf16_f32 v241, v238, v239
    buffer_store_dwordx2 v[240:241], v234, s[16:19], s61 offen
    ds_read_b128 v[244:247], v255 offset:96
    s_waitcnt lgkmcnt(0)
    v_mul_f32 v236, v253, v244
    v_fma_f32 v236, v172, v252, -v236
    v_mul_f32 v237, v253, v245
    v_fma_f32 v237, v173, v252, -v237
    v_mul_f32 v238, v253, v246
    v_fma_f32 v238, v174, v252, -v238
    v_mul_f32 v239, v253, v247
    v_fma_f32 v239, v175, v252, -v239
    v_cvt_pk_bf16_f32 v242, v236, v237
    v_cvt_pk_bf16_f32 v243, v238, v239
    buffer_store_dwordx2 v[242:243], v235, s[16:19], s61 offen
    v_add_u32 v254, 256, v254
    s_add_u32 s61, s61, s60
    s_mov_b32 s74, 81920
    v_add_u32 v224, s74, v224
    v_add_u32 v225, s74, v225
    v_add_u32 v226, s74, v226
    v_add_u32 v227, s74, v227
    v_add_u32 v228, s74, v228
    v_add_u32 v229, s74, v229
    v_add_u32 v230, s74, v230
    v_add_u32 v231, s74, v231
    s_mov_b32 s75, 4294885376
    s_mov_b32 s76, 40960
    s_mov_b32 s69, 2
    s_mov_b32 s70, 0
    s_waitcnt lgkmcnt(0)
    s_barrier
    ds_read_b128 v[192:195], v224 offset:0
    ds_read_b128 v[196:199], v225 offset:0
    ds_read_b128 v[200:203], v226 offset:0
    ds_read_b128 v[204:207], v227 offset:0
    ds_read_b128 v[208:211], v228 offset:0
    ds_read_b128 v[212:215], v229 offset:0
K1_LOOP_QK:
    s_add_u32 s69, s69, 1
    s_cmp_ge_u32 s69, 3
    s_cselect_b32 s74, s75, s76
    s_cselect_b32 s69, 0, s69
    s_waitcnt lgkmcnt(5)
    v_mfma_f32_32x32x16_bf16 v[160:175], v[0:3], v[192:195], 0
    ds_read_b128 v[216:219], v230 offset:0
    s_waitcnt lgkmcnt(5)
    v_mfma_f32_32x32x16_bf16 v[160:175], v[4:7], v[196:199], v[160:175]
    ds_read_b128 v[220:223], v231 offset:0
    s_waitcnt lgkmcnt(5)
    v_mfma_f32_32x32x16_bf16 v[160:175], v[8:11], v[200:203], v[160:175]
    ds_read_b128 v[192:195], v224 offset:256
    ds_read2_b32 v[252:253], v254 offset0:0 offset1:32
    ds_read_b128 v[244:247], v255 offset:0
    s_waitcnt lgkmcnt(7)
    v_mfma_f32_32x32x16_bf16 v[160:175], v[12:15], v[204:207], v[160:175]
    ds_read_b128 v[196:199], v225 offset:256
    s_waitcnt lgkmcnt(7)
    v_mfma_f32_32x32x16_bf16 v[160:175], v[16:19], v[208:211], v[160:175]
    ds_read_b128 v[200:203], v226 offset:256
    s_waitcnt lgkmcnt(7)
    v_mfma_f32_32x32x16_bf16 v[160:175], v[20:23], v[212:215], v[160:175]
    ds_read_b128 v[204:207], v227 offset:256
    s_waitcnt lgkmcnt(3)
    v_mul_f32 v252, s62, v252
    v_mul_f32 v253, s62, v253
    v_mfma_f32_32x32x16_bf16 v[160:175], v[24:27], v[216:219], v[160:175]
    ds_read_b128 v[208:211], v228 offset:256
    v_mul_f32 v236, v253, v244
    v_fma_f32 v236, v176, v252, -v236
    v_mfma_f32_32x32x16_bf16 v[160:175], v[28:31], v[220:223], v[160:175]
    ds_read_b128 v[212:215], v229 offset:256
    v_mul_f32 v237, v253, v245
    v_fma_f32 v237, v177, v252, -v237
    v_mul_f32 v238, v253, v246
    v_fma_f32 v238, v178, v252, -v238
    v_mfma_f32_32x32x16_bf16 v[160:175], v[32:35], v[192:195], v[160:175]
    ds_read_b128 v[216:219], v230 offset:256
    v_mul_f32 v239, v253, v247
    v_fma_f32 v239, v179, v252, -v239
    s_waitcnt lgkmcnt(5)
    v_mfma_f32_32x32x16_bf16 v[160:175], v[36:39], v[196:199], v[160:175]
    ds_read_b128 v[220:223], v231 offset:256
    v_cvt_pk_bf16_f32 v240, v236, v237
    v_cvt_pk_bf16_f32 v241, v238, v239
    buffer_store_dwordx2 v[240:241], v232, s[16:19], s61 offen
    s_waitcnt lgkmcnt(5)
    v_mfma_f32_32x32x16_bf16 v[160:175], v[40:43], v[200:203], v[160:175]
    ds_read_b128 v[192:195], v224 offset:512
    ds_read_b128 v[244:247], v255 offset:32
    s_waitcnt lgkmcnt(6)
    v_mfma_f32_32x32x16_bf16 v[160:175], v[44:47], v[204:207], v[160:175]
    ds_read_b128 v[196:199], v225 offset:512
    s_waitcnt lgkmcnt(6)
    v_mfma_f32_32x32x16_bf16 v[160:175], v[48:51], v[208:211], v[160:175]
    ds_read_b128 v[200:203], v226 offset:512
    s_waitcnt lgkmcnt(2)
    v_mfma_f32_32x32x16_bf16 v[160:175], v[52:55], v[212:215], v[160:175]
    ds_read_b128 v[204:207], v227 offset:512
    v_mul_f32 v236, v253, v244
    v_fma_f32 v236, v180, v252, -v236
    v_mfma_f32_32x32x16_bf16 v[160:175], v[56:59], v[216:219], v[160:175]
    ds_read_b128 v[208:211], v228 offset:512
    v_mul_f32 v237, v253, v245
    v_fma_f32 v237, v181, v252, -v237
    v_mfma_f32_32x32x16_bf16 v[160:175], v[60:63], v[220:223], v[160:175]
    ds_read_b128 v[212:215], v229 offset:512
    v_mul_f32 v238, v253, v246
    v_fma_f32 v238, v182, v252, -v238
    v_mfma_f32_32x32x16_bf16 v[160:175], v[64:67], v[192:195], v[160:175]
    ds_read_b128 v[216:219], v230 offset:512
    v_mul_f32 v239, v253, v247
    v_fma_f32 v239, v183, v252, -v239
    s_waitcnt lgkmcnt(5)
    v_mfma_f32_32x32x16_bf16 v[160:175], v[68:71], v[196:199], v[160:175]
    ds_read_b128 v[220:223], v231 offset:512
    v_cvt_pk_bf16_f32 v242, v236, v237
    v_cvt_pk_bf16_f32 v243, v238, v239
    buffer_store_dwordx2 v[242:243], v233, s[16:19], s61 offen
    ds_read_b128 v[244:247], v255 offset:64
    s_waitcnt lgkmcnt(6)
    v_mfma_f32_32x32x16_bf16 v[160:175], v[72:75], v[200:203], v[160:175]
    ds_read_b128 v[192:195], v224 offset:768
    s_waitcnt lgkmcnt(6)
    v_mfma_f32_32x32x16_bf16 v[160:175], v[76:79], v[204:207], v[160:175]
    ds_read_b128 v[196:199], v225 offset:768
    s_waitcnt lgkmcnt(6)
    v_mfma_f32_32x32x16_bf16 v[160:175], v[80:83], v[208:211], v[160:175]
    ds_read_b128 v[200:203], v226 offset:768
    s_waitcnt lgkmcnt(3)
    v_mfma_f32_32x32x16_bf16 v[160:175], v[84:87], v[212:215], v[160:175]
    ds_read_b128 v[204:207], v227 offset:768
    v_mul_f32 v236, v253, v244
    v_fma_f32 v236, v184, v252, -v236
    v_mfma_f32_32x32x16_bf16 v[160:175], v[88:91], v[216:219], v[160:175]
    ds_read_b128 v[208:211], v228 offset:768
    v_mul_f32 v237, v253, v245
    v_fma_f32 v237, v185, v252, -v237
    v_mul_f32 v238, v253, v246
    v_fma_f32 v238, v186, v252, -v238
    v_mfma_f32_32x32x16_bf16 v[160:175], v[92:95], v[220:223], v[160:175]
    ds_read_b128 v[212:215], v229 offset:768
    v_mul_f32 v239, v253, v247
    v_fma_f32 v239, v187, v252, -v239
    s_waitcnt lgkmcnt(5)
    v_mfma_f32_32x32x16_bf16 v[160:175], v[96:99], v[192:195], v[160:175]
    ds_read_b128 v[216:219], v230 offset:768
    v_cvt_pk_bf16_f32 v240, v236, v237
    v_cvt_pk_bf16_f32 v241, v238, v239
    buffer_store_dwordx2 v[240:241], v234, s[16:19], s61 offen
    s_waitcnt lgkmcnt(5)
    v_mfma_f32_32x32x16_bf16 v[160:175], v[100:103], v[196:199], v[160:175]
    ds_read_b128 v[220:223], v231 offset:768
    ds_read_b128 v[244:247], v255 offset:96
    s_waitcnt lgkmcnt(6)
    v_mfma_f32_32x32x16_bf16 v[160:175], v[104:107], v[200:203], v[160:175]
    ds_read_b128 v[192:195], v224 offset:1024
    s_waitcnt lgkmcnt(6)
    v_mfma_f32_32x32x16_bf16 v[160:175], v[108:111], v[204:207], v[160:175]
    ds_read_b128 v[196:199], v225 offset:1024
    s_waitcnt lgkmcnt(2)
    v_mfma_f32_32x32x16_bf16 v[160:175], v[112:115], v[208:211], v[160:175]
    ds_read_b128 v[200:203], v226 offset:1024
    v_mul_f32 v236, v253, v244
    v_fma_f32 v236, v188, v252, -v236
    v_mfma_f32_32x32x16_bf16 v[160:175], v[116:119], v[212:215], v[160:175]
    ds_read_b128 v[204:207], v227 offset:1024
    v_mul_f32 v237, v253, v245
    v_fma_f32 v237, v189, v252, -v237
    v_mfma_f32_32x32x16_bf16 v[160:175], v[120:123], v[216:219], v[160:175]
    ds_read_b128 v[208:211], v228 offset:1024
    v_mul_f32 v238, v253, v246
    v_fma_f32 v238, v190, v252, -v238
    v_mfma_f32_32x32x16_bf16 v[160:175], v[124:127], v[220:223], v[160:175]
    ds_read_b128 v[212:215], v229 offset:1024
    v_mul_f32 v239, v253, v247
    v_fma_f32 v239, v191, v252, -v239
    s_waitcnt lgkmcnt(5)
    v_mfma_f32_32x32x16_bf16 v[160:175], v[128:131], v[192:195], v[160:175]
    ds_read_b128 v[216:219], v230 offset:1024
    v_cvt_pk_bf16_f32 v242, v236, v237
    v_cvt_pk_bf16_f32 v243, v238, v239
    buffer_store_dwordx2 v[242:243], v235, s[16:19], s61 offen
    s_waitcnt lgkmcnt(5)
    v_mfma_f32_32x32x16_bf16 v[160:175], v[132:135], v[196:199], v[160:175]
    ds_read_b128 v[220:223], v231 offset:1024
    s_waitcnt lgkmcnt(5)
    v_mfma_f32_32x32x16_bf16 v[160:175], v[136:139], v[200:203], v[160:175]
    s_waitcnt lgkmcnt(4)
    v_mfma_f32_32x32x16_bf16 v[160:175], v[140:143], v[204:207], v[160:175]
    s_waitcnt lgkmcnt(0)
    s_barrier
    v_add_u32 v224, s74, v224
    v_add_u32 v225, s74, v225
    v_add_u32 v226, s74, v226
    v_add_u32 v227, s74, v227
    v_add_u32 v228, s74, v228
    v_add_u32 v229, s74, v229
    v_add_u32 v230, s74, v230
    v_add_u32 v231, s74, v231
    ds_read_b128 v[192:195], v224 offset:0
    ds_read_b128 v[196:199], v225 offset:0
    v_mfma_f32_32x32x16_bf16 v[160:175], v[144:147], v[208:211], v[160:175]
    ds_read_b128 v[200:203], v226 offset:0
    v_mfma_f32_32x32x16_bf16 v[160:175], v[148:151], v[212:215], v[160:175]
    ds_read_b128 v[204:207], v227 offset:0
    v_mfma_f32_32x32x16_bf16 v[160:175], v[152:155], v[216:219], v[160:175]
    ds_read_b128 v[208:211], v228 offset:0
    v_mfma_f32_32x32x16_bf16 v[160:175], v[156:159], v[220:223], v[160:175]
    ds_read_b128 v[212:215], v229 offset:0
    s_add_u32 s61, s61, s60
    v_add_u32 v254, 256, v254
    s_add_u32 s69, s69, 1
    s_cmp_ge_u32 s69, 3
    s_cselect_b32 s74, s75, s76
    s_cselect_b32 s69, 0, s69
    s_waitcnt lgkmcnt(5)
    v_mfma_f32_32x32x16_bf16 v[176:191], v[0:3], v[192:195], 0
    ds_read_b128 v[216:219], v230 offset:0
    s_waitcnt lgkmcnt(5)
    v_mfma_f32_32x32x16_bf16 v[176:191], v[4:7], v[196:199], v[176:191]
    ds_read_b128 v[220:223], v231 offset:0
    s_waitcnt lgkmcnt(5)
    v_mfma_f32_32x32x16_bf16 v[176:191], v[8:11], v[200:203], v[176:191]
    ds_read_b128 v[192:195], v224 offset:256
    ds_read2_b32 v[252:253], v254 offset0:0 offset1:32
    ds_read_b128 v[244:247], v255 offset:0
    s_waitcnt lgkmcnt(7)
    v_mfma_f32_32x32x16_bf16 v[176:191], v[12:15], v[204:207], v[176:191]
    ds_read_b128 v[196:199], v225 offset:256
    s_waitcnt lgkmcnt(7)
    v_mfma_f32_32x32x16_bf16 v[176:191], v[16:19], v[208:211], v[176:191]
    ds_read_b128 v[200:203], v226 offset:256
    s_waitcnt lgkmcnt(7)
    v_mfma_f32_32x32x16_bf16 v[176:191], v[20:23], v[212:215], v[176:191]
    ds_read_b128 v[204:207], v227 offset:256
    s_waitcnt lgkmcnt(3)
    v_mul_f32 v252, s62, v252
    v_mul_f32 v253, s62, v253
    v_mfma_f32_32x32x16_bf16 v[176:191], v[24:27], v[216:219], v[176:191]
    ds_read_b128 v[208:211], v228 offset:256
    v_mul_f32 v236, v253, v244
    v_fma_f32 v236, v160, v252, -v236
    v_mfma_f32_32x32x16_bf16 v[176:191], v[28:31], v[220:223], v[176:191]
    ds_read_b128 v[212:215], v229 offset:256
    v_mul_f32 v237, v253, v245
    v_fma_f32 v237, v161, v252, -v237
    v_mul_f32 v238, v253, v246
    v_fma_f32 v238, v162, v252, -v238
    v_mfma_f32_32x32x16_bf16 v[176:191], v[32:35], v[192:195], v[176:191]
    ds_read_b128 v[216:219], v230 offset:256
    v_mul_f32 v239, v253, v247
    v_fma_f32 v239, v163, v252, -v239
    s_waitcnt lgkmcnt(5)
    v_mfma_f32_32x32x16_bf16 v[176:191], v[36:39], v[196:199], v[176:191]
    ds_read_b128 v[220:223], v231 offset:256
    v_cvt_pk_bf16_f32 v240, v236, v237
    v_cvt_pk_bf16_f32 v241, v238, v239
    buffer_store_dwordx2 v[240:241], v232, s[16:19], s61 offen
    s_waitcnt lgkmcnt(5)
    v_mfma_f32_32x32x16_bf16 v[176:191], v[40:43], v[200:203], v[176:191]
    ds_read_b128 v[192:195], v224 offset:512
    ds_read_b128 v[244:247], v255 offset:32
    s_waitcnt lgkmcnt(6)
    v_mfma_f32_32x32x16_bf16 v[176:191], v[44:47], v[204:207], v[176:191]
    ds_read_b128 v[196:199], v225 offset:512
    s_waitcnt lgkmcnt(6)
    v_mfma_f32_32x32x16_bf16 v[176:191], v[48:51], v[208:211], v[176:191]
    ds_read_b128 v[200:203], v226 offset:512
    s_waitcnt lgkmcnt(2)
    v_mfma_f32_32x32x16_bf16 v[176:191], v[52:55], v[212:215], v[176:191]
    ds_read_b128 v[204:207], v227 offset:512
    v_mul_f32 v236, v253, v244
    v_fma_f32 v236, v164, v252, -v236
    v_mfma_f32_32x32x16_bf16 v[176:191], v[56:59], v[216:219], v[176:191]
    ds_read_b128 v[208:211], v228 offset:512
    v_mul_f32 v237, v253, v245
    v_fma_f32 v237, v165, v252, -v237
    v_mfma_f32_32x32x16_bf16 v[176:191], v[60:63], v[220:223], v[176:191]
    ds_read_b128 v[212:215], v229 offset:512
    v_mul_f32 v238, v253, v246
    v_fma_f32 v238, v166, v252, -v238
    v_mfma_f32_32x32x16_bf16 v[176:191], v[64:67], v[192:195], v[176:191]
    ds_read_b128 v[216:219], v230 offset:512
    v_mul_f32 v239, v253, v247
    v_fma_f32 v239, v167, v252, -v239
    s_waitcnt lgkmcnt(5)
    v_mfma_f32_32x32x16_bf16 v[176:191], v[68:71], v[196:199], v[176:191]
    ds_read_b128 v[220:223], v231 offset:512
    v_cvt_pk_bf16_f32 v242, v236, v237
    v_cvt_pk_bf16_f32 v243, v238, v239
    buffer_store_dwordx2 v[242:243], v233, s[16:19], s61 offen
    ds_read_b128 v[244:247], v255 offset:64
    s_waitcnt lgkmcnt(6)
    v_mfma_f32_32x32x16_bf16 v[176:191], v[72:75], v[200:203], v[176:191]
    ds_read_b128 v[192:195], v224 offset:768
    s_waitcnt lgkmcnt(6)
    v_mfma_f32_32x32x16_bf16 v[176:191], v[76:79], v[204:207], v[176:191]
    ds_read_b128 v[196:199], v225 offset:768
    s_waitcnt lgkmcnt(6)
    v_mfma_f32_32x32x16_bf16 v[176:191], v[80:83], v[208:211], v[176:191]
    ds_read_b128 v[200:203], v226 offset:768
    s_waitcnt lgkmcnt(3)
    v_mfma_f32_32x32x16_bf16 v[176:191], v[84:87], v[212:215], v[176:191]
    ds_read_b128 v[204:207], v227 offset:768
    v_mul_f32 v236, v253, v244
    v_fma_f32 v236, v168, v252, -v236
    v_mfma_f32_32x32x16_bf16 v[176:191], v[88:91], v[216:219], v[176:191]
    ds_read_b128 v[208:211], v228 offset:768
    v_mul_f32 v237, v253, v245
    v_fma_f32 v237, v169, v252, -v237
    v_mul_f32 v238, v253, v246
    v_fma_f32 v238, v170, v252, -v238
    v_mfma_f32_32x32x16_bf16 v[176:191], v[92:95], v[220:223], v[176:191]
    ds_read_b128 v[212:215], v229 offset:768
    v_mul_f32 v239, v253, v247
    v_fma_f32 v239, v171, v252, -v239
    s_waitcnt lgkmcnt(5)
    v_mfma_f32_32x32x16_bf16 v[176:191], v[96:99], v[192:195], v[176:191]
    ds_read_b128 v[216:219], v230 offset:768
    v_cvt_pk_bf16_f32 v240, v236, v237
    v_cvt_pk_bf16_f32 v241, v238, v239
    buffer_store_dwordx2 v[240:241], v234, s[16:19], s61 offen
    s_waitcnt lgkmcnt(5)
    v_mfma_f32_32x32x16_bf16 v[176:191], v[100:103], v[196:199], v[176:191]
    ds_read_b128 v[220:223], v231 offset:768
    ds_read_b128 v[244:247], v255 offset:96
    s_waitcnt lgkmcnt(6)
    v_mfma_f32_32x32x16_bf16 v[176:191], v[104:107], v[200:203], v[176:191]
    ds_read_b128 v[192:195], v224 offset:1024
    s_waitcnt lgkmcnt(6)
    v_mfma_f32_32x32x16_bf16 v[176:191], v[108:111], v[204:207], v[176:191]
    ds_read_b128 v[196:199], v225 offset:1024
    s_waitcnt lgkmcnt(2)
    v_mfma_f32_32x32x16_bf16 v[176:191], v[112:115], v[208:211], v[176:191]
    ds_read_b128 v[200:203], v226 offset:1024
    v_mul_f32 v236, v253, v244
    v_fma_f32 v236, v172, v252, -v236
    v_mfma_f32_32x32x16_bf16 v[176:191], v[116:119], v[212:215], v[176:191]
    ds_read_b128 v[204:207], v227 offset:1024
    v_mul_f32 v237, v253, v245
    v_fma_f32 v237, v173, v252, -v237
    v_mfma_f32_32x32x16_bf16 v[176:191], v[120:123], v[216:219], v[176:191]
    ds_read_b128 v[208:211], v228 offset:1024
    v_mul_f32 v238, v253, v246
    v_fma_f32 v238, v174, v252, -v238
    v_mfma_f32_32x32x16_bf16 v[176:191], v[124:127], v[220:223], v[176:191]
    ds_read_b128 v[212:215], v229 offset:1024
    v_mul_f32 v239, v253, v247
    v_fma_f32 v239, v175, v252, -v239
    s_waitcnt lgkmcnt(5)
    v_mfma_f32_32x32x16_bf16 v[176:191], v[128:131], v[192:195], v[176:191]
    ds_read_b128 v[216:219], v230 offset:1024
    v_cvt_pk_bf16_f32 v242, v236, v237
    v_cvt_pk_bf16_f32 v243, v238, v239
    buffer_store_dwordx2 v[242:243], v235, s[16:19], s61 offen
    s_waitcnt lgkmcnt(5)
    v_mfma_f32_32x32x16_bf16 v[176:191], v[132:135], v[196:199], v[176:191]
    ds_read_b128 v[220:223], v231 offset:1024
    s_waitcnt lgkmcnt(5)
    v_mfma_f32_32x32x16_bf16 v[176:191], v[136:139], v[200:203], v[176:191]
    s_waitcnt lgkmcnt(4)
    v_mfma_f32_32x32x16_bf16 v[176:191], v[140:143], v[204:207], v[176:191]
    s_waitcnt lgkmcnt(0)
    s_cmp_eq_u32 s70, 2
    s_cbranch_scc1 K1_LOOP_QK_nb
    s_barrier
K1_LOOP_QK_nb:
    v_add_u32 v224, s74, v224
    v_add_u32 v225, s74, v225
    v_add_u32 v226, s74, v226
    v_add_u32 v227, s74, v227
    v_add_u32 v228, s74, v228
    v_add_u32 v229, s74, v229
    v_add_u32 v230, s74, v230
    v_add_u32 v231, s74, v231
    ds_read_b128 v[192:195], v224 offset:0
    ds_read_b128 v[196:199], v225 offset:0
    v_mfma_f32_32x32x16_bf16 v[176:191], v[144:147], v[208:211], v[176:191]
    ds_read_b128 v[200:203], v226 offset:0
    v_mfma_f32_32x32x16_bf16 v[176:191], v[148:151], v[212:215], v[176:191]
    ds_read_b128 v[204:207], v227 offset:0
    v_mfma_f32_32x32x16_bf16 v[176:191], v[152:155], v[216:219], v[176:191]
    ds_read_b128 v[208:211], v228 offset:0
    v_mfma_f32_32x32x16_bf16 v[176:191], v[156:159], v[220:223], v[176:191]
    ds_read_b128 v[212:215], v229 offset:0
    s_add_u32 s61, s61, s60
    v_add_u32 v254, 256, v254
    s_add_u32 s70, s70, 1
    s_cmp_lt_u32 s70, 3
    s_cbranch_scc1 K1_LOOP_QK
    s_waitcnt lgkmcnt(0)
    s_nop 7
    s_nop 7
    ds_read2_b32 v[252:253], v254 offset0:0 offset1:32
    ds_read_b128 v[244:247], v255 offset:0
    s_waitcnt lgkmcnt(0)
    v_mul_f32 v252, s62, v252
    v_mul_f32 v253, s62, v253
    v_mul_f32 v236, v253, v244
    v_fma_f32 v236, v176, v252, -v236
    v_mul_f32 v237, v253, v245
    v_fma_f32 v237, v177, v252, -v237
    v_mul_f32 v238, v253, v246
    v_fma_f32 v238, v178, v252, -v238
    v_mul_f32 v239, v253, v247
    v_fma_f32 v239, v179, v252, -v239
    v_cvt_pk_bf16_f32 v240, v236, v237
    v_cvt_pk_bf16_f32 v241, v238, v239
    buffer_store_dwordx2 v[240:241], v232, s[16:19], s61 offen
    ds_read_b128 v[244:247], v255 offset:32
    s_waitcnt lgkmcnt(0)
    v_mul_f32 v236, v253, v244
    v_fma_f32 v236, v180, v252, -v236
    v_mul_f32 v237, v253, v245
    v_fma_f32 v237, v181, v252, -v237
    v_mul_f32 v238, v253, v246
    v_fma_f32 v238, v182, v252, -v238
    v_mul_f32 v239, v253, v247
    v_fma_f32 v239, v183, v252, -v239
    v_cvt_pk_bf16_f32 v242, v236, v237
    v_cvt_pk_bf16_f32 v243, v238, v239
    buffer_store_dwordx2 v[242:243], v233, s[16:19], s61 offen
    ds_read_b128 v[244:247], v255 offset:64
    s_waitcnt lgkmcnt(0)
    v_mul_f32 v236, v253, v244
    v_fma_f32 v236, v184, v252, -v236
    v_mul_f32 v237, v253, v245
    v_fma_f32 v237, v185, v252, -v237
    v_mul_f32 v238, v253, v246
    v_fma_f32 v238, v186, v252, -v238
    v_mul_f32 v239, v253, v247
    v_fma_f32 v239, v187, v252, -v239
    v_cvt_pk_bf16_f32 v240, v236, v237
    v_cvt_pk_bf16_f32 v241, v238, v239
    buffer_store_dwordx2 v[240:241], v234, s[16:19], s61 offen
    ds_read_b128 v[244:247], v255 offset:96
    s_waitcnt lgkmcnt(0)
    v_mul_f32 v236, v253, v244
    v_fma_f32 v236, v188, v252, -v236
    v_mul_f32 v237, v253, v245
    v_fma_f32 v237, v189, v252, -v237
    v_mul_f32 v238, v253, v246
    v_fma_f32 v238, v190, v252, -v238
    v_mul_f32 v239, v253, v247
    v_fma_f32 v239, v191, v252, -v239
    v_cvt_pk_bf16_f32 v242, v236, v237
    v_cvt_pk_bf16_f32 v243, v238, v239
    buffer_store_dwordx2 v[242:243], v235, s[16:19], s61 offen
    s_endpgm
K1_V:
    v_and_b32 v10, 31, v243
    v_lshrrev_b32 v11, 5, v243
    s_sub_u32 s57, s38, 10
    s_lshl_b32 s57, s57, 7
    s_lshl_b32 s58, s41, 5
    s_add_u32 s57, s57, s58
    v_add_u32 v13, s57, v10
    v_mul_u32_u24 v14, 3277, v13
    v_lshrrev_b32 v14, 16, v14
    v_mul_u32_u24 v12, 20, v14
    v_sub_u32 v13, v13, v12
    v_mul_u32_u24 v14, 81920, v14
    v_lshl_add_u32 v14, v13, 6, v14
    v_lshl_add_u32 v232, v11, 4, v14
    s_mul_i32 s59, s39, 1280
    s_add_u32 s59, s59, 8388608
    s_movk_i32 s60, 1280
    v_lshlrev_b32 v254, 4, v11
    v_add_u32 v254, 155648, v254
    s_lshl_b32 s51, s41, 7
    s_add_u32 s51, s51, 157696
    v_lshlrev_b32 v255, 4, v11
    v_add_u32 v255, s51, v255
    v_lshlrev_b32 v252, 2, v10
    v_add_u32 v252, s51, v252
    s_waitcnt vmcnt(0)
    s_barrier
    ds_read_b64_tr_b16 v[0:1], v237 offset:0
    ds_read_b64_tr_b16 v[2:3], v237 offset:1024
    ds_read_b64_tr_b16 v[4:5], v237 offset:4096
    ds_read_b64_tr_b16 v[6:7], v237 offset:5120
    ds_read_b64_tr_b16 v[8:9], v237 offset:8192
    ds_read_b64_tr_b16 v[10:11], v237 offset:9216
    ds_read_b64_tr_b16 v[12:13], v237 offset:12288
    ds_read_b64_tr_b16 v[14:15], v237 offset:13312
    ds_read_b128 v[192:195], v224 offset:0
    ds_read_b128 v[196:199], v225 offset:0
    ds_read_b128 v[200:203], v226 offset:0
    ds_read_b128 v[204:207], v227 offset:0
    ds_read_b128 v[208:211], v224 offset:40960
    ds_read_b128 v[212:215], v225 offset:40960
    ds_read_b128 v[216:219], v226 offset:40960
    ds_read_b128 v[220:223], v227 offset:40960
    s_waitcnt lgkmcnt(8)
    s_barrier
    ds_read_b64_tr_b16 v[16:17], v237 offset:16384
    ds_read_b64_tr_b16 v[18:19], v237 offset:17408
    ds_read_b64_tr_b16 v[20:21], v237 offset:20480
    ds_read_b64_tr_b16 v[22:23], v237 offset:21504
    ds_read_b64_tr_b16 v[24:25], v237 offset:24576
    ds_read_b64_tr_b16 v[26:27], v237 offset:25600
    ds_read_b64_tr_b16 v[28:29], v237 offset:28672
    ds_read_b64_tr_b16 v[30:31], v237 offset:29696
    s_waitcnt lgkmcnt(8)
    v_dot2c_f32_bf16 v238, v239, v0
    v_dot2c_f32_bf16 v238, v239, v1
    v_dot2c_f32_bf16 v238, v239, v2
    v_dot2c_f32_bf16 v238, v239, v3
    v_dot2c_f32_bf16 v238, v239, v4
    v_dot2c_f32_bf16 v238, v239, v5
    v_dot2c_f32_bf16 v238, v239, v6
    v_dot2c_f32_bf16 v238, v239, v7
    v_dot2c_f32_bf16 v238, v239, v8
    v_dot2c_f32_bf16 v238, v239, v9
    v_dot2c_f32_bf16 v238, v239, v10
    v_dot2c_f32_bf16 v238, v239, v11
    v_dot2c_f32_bf16 v238, v239, v12
    v_dot2c_f32_bf16 v238, v239, v13
    v_dot2c_f32_bf16 v238, v239, v14
    v_dot2c_f32_bf16 v238, v239, v15
    v_mfma_f32_32x32x16_bf16 v[160:175], v[192:195], v[0:3], 0
    ds_read_b128 v[192:195], v228 offset:0
    v_mfma_f32_32x32x16_bf16 v[176:191], v[208:211], v[0:3], 0
    ds_read_b128 v[208:211], v228 offset:40960
    v_mfma_f32_32x32x16_bf16 v[160:175], v[196:199], v[4:7], v[160:175]
    ds_read_b128 v[196:199], v229 offset:0
    v_mfma_f32_32x32x16_bf16 v[176:191], v[212:215], v[4:7], v[176:191]
    ds_read_b128 v[212:215], v229 offset:40960
    v_mfma_f32_32x32x16_bf16 v[160:175], v[200:203], v[8:11], v[160:175]
    ds_read_b128 v[200:203], v230 offset:0
    v_mfma_f32_32x32x16_bf16 v[176:191], v[216:219], v[8:11], v[176:191]
    ds_read_b128 v[216:219], v230 offset:40960
    v_mfma_f32_32x32x16_bf16 v[160:175], v[204:207], v[12:15], v[160:175]
    ds_read_b128 v[204:207], v231 offset:0
    v_mfma_f32_32x32x16_bf16 v[176:191], v[220:223], v[12:15], v[176:191]
    ds_read_b128 v[220:223], v231 offset:40960
    s_waitcnt lgkmcnt(8)
    s_barrier
    ds_read_b64_tr_b16 v[32:33], v236 offset:0
    ds_read_b64_tr_b16 v[34:35], v236 offset:1024
    ds_read_b64_tr_b16 v[36:37], v236 offset:4096
    ds_read_b64_tr_b16 v[38:39], v236 offset:5120
    ds_read_b64_tr_b16 v[40:41], v236 offset:8192
    ds_read_b64_tr_b16 v[42:43], v236 offset:9216
    ds_read_b64_tr_b16 v[44:45], v236 offset:12288
    ds_read_b64_tr_b16 v[46:47], v236 offset:13312
    s_waitcnt lgkmcnt(8)
    v_dot2c_f32_bf16 v238, v239, v16
    v_dot2c_f32_bf16 v238, v239, v17
    v_dot2c_f32_bf16 v238, v239, v18
    v_dot2c_f32_bf16 v238, v239, v19
    v_dot2c_f32_bf16 v238, v239, v20
    v_dot2c_f32_bf16 v238, v239, v21
    v_dot2c_f32_bf16 v238, v239, v22
    v_dot2c_f32_bf16 v238, v239, v23
    v_dot2c_f32_bf16 v238, v239, v24
    v_dot2c_f32_bf16 v238, v239, v25
    v_dot2c_f32_bf16 v238, v239, v26
    v_dot2c_f32_bf16 v238, v239, v27
    v_dot2c_f32_bf16 v238, v239, v28
    v_dot2c_f32_bf16 v238, v239, v29
    v_dot2c_f32_bf16 v238, v239, v30
    v_dot2c_f32_bf16 v238, v239, v31
    v_mfma_f32_32x32x16_bf16 v[160:175], v[192:195], v[16:19], v[160:175]
    ds_read_b128 v[192:195], v224 offset:256
    v_mfma_f32_32x32x16_bf16 v[176:191], v[208:211], v[16:19], v[176:191]
    ds_read_b128 v[208:211], v224 offset:41216
    v_mfma_f32_32x32x16_bf16 v[160:175], v[196:199], v[20:23], v[160:175]
    ds_read_b128 v[196:199], v225 offset:256
    v_mfma_f32_32x32x16_bf16 v[176:191], v[212:215], v[20:23], v[176:191]
    ds_read_b128 v[212:215], v225 offset:41216
    v_mfma_f32_32x32x16_bf16 v[160:175], v[200:203], v[24:27], v[160:175]
    ds_read_b128 v[200:203], v226 offset:256
    v_mfma_f32_32x32x16_bf16 v[176:191], v[216:219], v[24:27], v[176:191]
    ds_read_b128 v[216:219], v226 offset:41216
    v_mfma_f32_32x32x16_bf16 v[160:175], v[204:207], v[28:31], v[160:175]
    ds_read_b128 v[204:207], v227 offset:256
    v_mfma_f32_32x32x16_bf16 v[176:191], v[220:223], v[28:31], v[176:191]
    ds_read_b128 v[220:223], v227 offset:41216
    s_waitcnt lgkmcnt(8)
    s_barrier
    ds_read_b64_tr_b16 v[48:49], v236 offset:16384
    ds_read_b64_tr_b16 v[50:51], v236 offset:17408
    ds_read_b64_tr_b16 v[52:53], v236 offset:20480
    ds_read_b64_tr_b16 v[54:55], v236 offset:21504
    ds_read_b64_tr_b16 v[56:57], v236 offset:24576
    ds_read_b64_tr_b16 v[58:59], v236 offset:25600
    ds_read_b64_tr_b16 v[60:61], v236 offset:28672
    ds_read_b64_tr_b16 v[62:63], v236 offset:29696
    s_waitcnt lgkmcnt(8)
    v_dot2c_f32_bf16 v238, v239, v32
    v_dot2c_f32_bf16 v238, v239, v33
    v_dot2c_f32_bf16 v238, v239, v34
    v_dot2c_f32_bf16 v238, v239, v35
    v_dot2c_f32_bf16 v238, v239, v36
    v_dot2c_f32_bf16 v238, v239, v37
    v_dot2c_f32_bf16 v238, v239, v38
    v_dot2c_f32_bf16 v238, v239, v39
    v_dot2c_f32_bf16 v238, v239, v40
    v_dot2c_f32_bf16 v238, v239, v41
    v_dot2c_f32_bf16 v238, v239, v42
    v_dot2c_f32_bf16 v238, v239, v43
    v_dot2c_f32_bf16 v238, v239, v44
    v_dot2c_f32_bf16 v238, v239, v45
    v_dot2c_f32_bf16 v238, v239, v46
    v_dot2c_f32_bf16 v238, v239, v47
    v_mfma_f32_32x32x16_bf16 v[160:175], v[192:195], v[32:35], v[160:175]
    ds_read_b128 v[192:195], v228 offset:256
    v_mfma_f32_32x32x16_bf16 v[176:191], v[208:211], v[32:35], v[176:191]
    ds_read_b128 v[208:211], v228 offset:41216
    v_mfma_f32_32x32x16_bf16 v[160:175], v[196:199], v[36:39], v[160:175]
    ds_read_b128 v[196:199], v229 offset:256
    v_mfma_f32_32x32x16_bf16 v[176:191], v[212:215], v[36:39], v[176:191]
    ds_read_b128 v[212:215], v229 offset:41216
    v_mfma_f32_32x32x16_bf16 v[160:175], v[200:203], v[40:43], v[160:175]
    ds_read_b128 v[200:203], v230 offset:256
    v_mfma_f32_32x32x16_bf16 v[176:191], v[216:219], v[40:43], v[176:191]
    ds_read_b128 v[216:219], v230 offset:41216
    v_mfma_f32_32x32x16_bf16 v[160:175], v[204:207], v[44:47], v[160:175]
    ds_read_b128 v[204:207], v231 offset:256
    v_mfma_f32_32x32x16_bf16 v[176:191], v[220:223], v[44:47], v[176:191]
    ds_read_b128 v[220:223], v231 offset:41216
    s_waitcnt lgkmcnt(8)
    s_barrier
    ds_read_b64_tr_b16 v[64:65], v237 offset:0
    ds_read_b64_tr_b16 v[66:67], v237 offset:1024
    ds_read_b64_tr_b16 v[68:69], v237 offset:4096
    ds_read_b64_tr_b16 v[70:71], v237 offset:5120
    ds_read_b64_tr_b16 v[72:73], v237 offset:8192
    ds_read_b64_tr_b16 v[74:75], v237 offset:9216
    ds_read_b64_tr_b16 v[76:77], v237 offset:12288
    ds_read_b64_tr_b16 v[78:79], v237 offset:13312
    s_waitcnt lgkmcnt(8)
    v_dot2c_f32_bf16 v238, v239, v48
    v_dot2c_f32_bf16 v238, v239, v49
    v_dot2c_f32_bf16 v238, v239, v50
    v_dot2c_f32_bf16 v238, v239, v51
    v_dot2c_f32_bf16 v238, v239, v52
    v_dot2c_f32_bf16 v238, v239, v53
    v_dot2c_f32_bf16 v238, v239, v54
    v_dot2c_f32_bf16 v238, v239, v55
    v_dot2c_f32_bf16 v238, v239, v56
    v_dot2c_f32_bf16 v238, v239, v57
    v_dot2c_f32_bf16 v238, v239, v58
    v_dot2c_f32_bf16 v238, v239, v59
    v_dot2c_f32_bf16 v238, v239, v60
    v_dot2c_f32_bf16 v238, v239, v61
    v_dot2c_f32_bf16 v238, v239, v62
    v_dot2c_f32_bf16 v238, v239, v63
    v_mfma_f32_32x32x16_bf16 v[160:175], v[192:195], v[48:51], v[160:175]
    ds_read_b128 v[192:195], v224 offset:512
    v_mfma_f32_32x32x16_bf16 v[176:191], v[208:211], v[48:51], v[176:191]
    ds_read_b128 v[208:211], v224 offset:41472
    v_mfma_f32_32x32x16_bf16 v[160:175], v[196:199], v[52:55], v[160:175]
    ds_read_b128 v[196:199], v225 offset:512
    v_mfma_f32_32x32x16_bf16 v[176:191], v[212:215], v[52:55], v[176:191]
    ds_read_b128 v[212:215], v225 offset:41472
    v_mfma_f32_32x32x16_bf16 v[160:175], v[200:203], v[56:59], v[160:175]
    ds_read_b128 v[200:203], v226 offset:512
    v_mfma_f32_32x32x16_bf16 v[176:191], v[216:219], v[56:59], v[176:191]
    ds_read_b128 v[216:219], v226 offset:41472
    v_mfma_f32_32x32x16_bf16 v[160:175], v[204:207], v[60:63], v[160:175]
    ds_read_b128 v[204:207], v227 offset:512
    v_mfma_f32_32x32x16_bf16 v[176:191], v[220:223], v[60:63], v[176:191]
    ds_read_b128 v[220:223], v227 offset:41472
    s_waitcnt lgkmcnt(8)
    s_barrier
    ds_read_b64_tr_b16 v[80:81], v237 offset:16384
    ds_read_b64_tr_b16 v[82:83], v237 offset:17408
    ds_read_b64_tr_b16 v[84:85], v237 offset:20480
    ds_read_b64_tr_b16 v[86:87], v237 offset:21504
    ds_read_b64_tr_b16 v[88:89], v237 offset:24576
    ds_read_b64_tr_b16 v[90:91], v237 offset:25600
    ds_read_b64_tr_b16 v[92:93], v237 offset:28672
    ds_read_b64_tr_b16 v[94:95], v237 offset:29696
    s_waitcnt lgkmcnt(8)
    v_dot2c_f32_bf16 v238, v239, v64
    v_dot2c_f32_bf16 v238, v239, v65
    v_dot2c_f32_bf16 v238, v239, v66
    v_dot2c_f32_bf16 v238, v239, v67
    v_dot2c_f32_bf16 v238, v239, v68
    v_dot2c_f32_bf16 v238, v239, v69
    v_dot2c_f32_bf16 v238, v239, v70
    v_dot2c_f32_bf16 v238, v239, v71
    v_dot2c_f32_bf16 v238, v239, v72
    v_dot2c_f32_bf16 v238, v239, v73
    v_dot2c_f32_bf16 v238, v239, v74
    v_dot2c_f32_bf16 v238, v239, v75
    v_dot2c_f32_bf16 v238, v239, v76
    v_dot2c_f32_bf16 v238, v239, v77
    v_dot2c_f32_bf16 v238, v239, v78
    v_dot2c_f32_bf16 v238, v239, v79
    v_mfma_f32_32x32x16_bf16 v[160:175], v[192:195], v[64:67], v[160:175]
    ds_read_b128 v[192:195], v228 offset:512
    v_mfma_f32_32x32x16_bf16 v[176:191], v[208:211], v[64:67], v[176:191]
    ds_read_b128 v[208:211], v228 offset:41472
    v_mfma_f32_32x32x16_bf16 v[160:175], v[196:199], v[68:71], v[160:175]
    ds_read_b128 v[196:199], v229 offset:512
    v_mfma_f32_32x32x16_bf16 v[176:191], v[212:215], v[68:71], v[176:191]
    ds_read_b128 v[212:215], v229 offset:41472
    v_mfma_f32_32x32x16_bf16 v[160:175], v[200:203], v[72:75], v[160:175]
    ds_read_b128 v[200:203], v230 offset:512
    v_mfma_f32_32x32x16_bf16 v[176:191], v[216:219], v[72:75], v[176:191]
    ds_read_b128 v[216:219], v230 offset:41472
    v_mfma_f32_32x32x16_bf16 v[160:175], v[204:207], v[76:79], v[160:175]
    ds_read_b128 v[204:207], v231 offset:512
    v_mfma_f32_32x32x16_bf16 v[176:191], v[220:223], v[76:79], v[176:191]
    ds_read_b128 v[220:223], v231 offset:41472
    s_waitcnt lgkmcnt(8)
    s_barrier
    ds_read_b64_tr_b16 v[96:97], v236 offset:0
    ds_read_b64_tr_b16 v[98:99], v236 offset:1024
    ds_read_b64_tr_b16 v[100:101], v236 offset:4096
    ds_read_b64_tr_b16 v[102:103], v236 offset:5120
    ds_read_b64_tr_b16 v[104:105], v236 offset:8192
    ds_read_b64_tr_b16 v[106:107], v236 offset:9216
    ds_read_b64_tr_b16 v[108:109], v236 offset:12288
    ds_read_b64_tr_b16 v[110:111], v236 offset:13312
    s_waitcnt lgkmcnt(8)
    v_dot2c_f32_bf16 v238, v239, v80
    v_dot2c_f32_bf16 v238, v239, v81
    v_dot2c_f32_bf16 v238, v239, v82
    v_dot2c_f32_bf16 v238, v239, v83
    v_dot2c_f32_bf16 v238, v239, v84
    v_dot2c_f32_bf16 v238, v239, v85
    v_dot2c_f32_bf16 v238, v239, v86
    v_dot2c_f32_bf16 v238, v239, v87
    v_dot2c_f32_bf16 v238, v239, v88
    v_dot2c_f32_bf16 v238, v239, v89
    v_dot2c_f32_bf16 v238, v239, v90
    v_dot2c_f32_bf16 v238, v239, v91
    v_dot2c_f32_bf16 v238, v239, v92
    v_dot2c_f32_bf16 v238, v239, v93
    v_dot2c_f32_bf16 v238, v239, v94
    v_dot2c_f32_bf16 v238, v239, v95
    v_mfma_f32_32x32x16_bf16 v[160:175], v[192:195], v[80:83], v[160:175]
    ds_read_b128 v[192:195], v224 offset:768
    v_mfma_f32_32x32x16_bf16 v[176:191], v[208:211], v[80:83], v[176:191]
    ds_read_b128 v[208:211], v224 offset:41728
    v_mfma_f32_32x32x16_bf16 v[160:175], v[196:199], v[84:87], v[160:175]
    ds_read_b128 v[196:199], v225 offset:768
    v_mfma_f32_32x32x16_bf16 v[176:191], v[212:215], v[84:87], v[176:191]
    ds_read_b128 v[212:215], v225 offset:41728
    v_mfma_f32_32x32x16_bf16 v[160:175], v[200:203], v[88:91], v[160:175]
    ds_read_b128 v[200:203], v226 offset:768
    v_mfma_f32_32x32x16_bf16 v[176:191], v[216:219], v[88:91], v[176:191]
    ds_read_b128 v[216:219], v226 offset:41728
    v_mfma_f32_32x32x16_bf16 v[160:175], v[204:207], v[92:95], v[160:175]
    ds_read_b128 v[204:207], v227 offset:768
    v_mfma_f32_32x32x16_bf16 v[176:191], v[220:223], v[92:95], v[176:191]
    ds_read_b128 v[220:223], v227 offset:41728
    s_waitcnt lgkmcnt(8)
    s_barrier
    ds_read_b64_tr_b16 v[112:113], v236 offset:16384
    ds_read_b64_tr_b16 v[114:115], v236 offset:17408
    ds_read_b64_tr_b16 v[116:117], v236 offset:20480
    ds_read_b64_tr_b16 v[118:119], v236 offset:21504
    ds_read_b64_tr_b16 v[120:121], v236 offset:24576
    ds_read_b64_tr_b16 v[122:123], v236 offset:25600
    ds_read_b64_tr_b16 v[124:125], v236 offset:28672
    ds_read_b64_tr_b16 v[126:127], v236 offset:29696
    s_waitcnt lgkmcnt(8)
    v_dot2c_f32_bf16 v238, v239, v96
    v_dot2c_f32_bf16 v238, v239, v97
    v_dot2c_f32_bf16 v238, v239, v98
    v_dot2c_f32_bf16 v238, v239, v99
    v_dot2c_f32_bf16 v238, v239, v100
    v_dot2c_f32_bf16 v238, v239, v101
    v_dot2c_f32_bf16 v238, v239, v102
    v_dot2c_f32_bf16 v238, v239, v103
    v_dot2c_f32_bf16 v238, v239, v104
    v_dot2c_f32_bf16 v238, v239, v105
    v_dot2c_f32_bf16 v238, v239, v106
    v_dot2c_f32_bf16 v238, v239, v107
    v_dot2c_f32_bf16 v238, v239, v108
    v_dot2c_f32_bf16 v238, v239, v109
    v_dot2c_f32_bf16 v238, v239, v110
    v_dot2c_f32_bf16 v238, v239, v111
    v_mfma_f32_32x32x16_bf16 v[160:175], v[192:195], v[96:99], v[160:175]
    ds_read_b128 v[192:195], v228 offset:768
    v_mfma_f32_32x32x16_bf16 v[176:191], v[208:211], v[96:99], v[176:191]
    ds_read_b128 v[208:211], v228 offset:41728
    v_mfma_f32_32x32x16_bf16 v[160:175], v[196:199], v[100:103], v[160:175]
    ds_read_b128 v[196:199], v229 offset:768
    v_mfma_f32_32x32x16_bf16 v[176:191], v[212:215], v[100:103], v[176:191]
    ds_read_b128 v[212:215], v229 offset:41728
    v_mfma_f32_32x32x16_bf16 v[160:175], v[200:203], v[104:107], v[160:175]
    ds_read_b128 v[200:203], v230 offset:768
    v_mfma_f32_32x32x16_bf16 v[176:191], v[216:219], v[104:107], v[176:191]
    ds_read_b128 v[216:219], v230 offset:41728
    v_mfma_f32_32x32x16_bf16 v[160:175], v[204:207], v[108:111], v[160:175]
    ds_read_b128 v[204:207], v231 offset:768
    v_mfma_f32_32x32x16_bf16 v[176:191], v[220:223], v[108:111], v[176:191]
    ds_read_b128 v[220:223], v231 offset:41728
    s_waitcnt lgkmcnt(8)
    s_barrier
    ds_read_b64_tr_b16 v[128:129], v237 offset:0
    ds_read_b64_tr_b16 v[130:131], v237 offset:1024
    ds_read_b64_tr_b16 v[132:133], v237 offset:4096
    ds_read_b64_tr_b16 v[134:135], v237 offset:5120
    ds_read_b64_tr_b16 v[136:137], v237 offset:8192
    ds_read_b64_tr_b16 v[138:139], v237 offset:9216
    ds_read_b64_tr_b16 v[140:141], v237 offset:12288
    ds_read_b64_tr_b16 v[142:143], v237 offset:13312
    s_waitcnt lgkmcnt(8)
    v_dot2c_f32_bf16 v238, v239, v112
    v_dot2c_f32_bf16 v238, v239, v113
    v_dot2c_f32_bf16 v238, v239, v114
    v_dot2c_f32_bf16 v238, v239, v115
    v_dot2c_f32_bf16 v238, v239, v116
    v_dot2c_f32_bf16 v238, v239, v117
    v_dot2c_f32_bf16 v238, v239, v118
    v_dot2c_f32_bf16 v238, v239, v119
    v_dot2c_f32_bf16 v238, v239, v120
    v_dot2c_f32_bf16 v238, v239, v121
    v_dot2c_f32_bf16 v238, v239, v122
    v_dot2c_f32_bf16 v238, v239, v123
    v_dot2c_f32_bf16 v238, v239, v124
    v_dot2c_f32_bf16 v238, v239, v125
    v_dot2c_f32_bf16 v238, v239, v126
    v_dot2c_f32_bf16 v238, v239, v127
    v_mfma_f32_32x32x16_bf16 v[160:175], v[192:195], v[112:115], v[160:175]
    ds_read_b128 v[192:195], v224 offset:1024
    v_mfma_f32_32x32x16_bf16 v[176:191], v[208:211], v[112:115], v[176:191]
    ds_read_b128 v[208:211], v224 offset:41984
    v_mfma_f32_32x32x16_bf16 v[160:175], v[196:199], v[116:119], v[160:175]
    ds_read_b128 v[196:199], v225 offset:1024
    v_mfma_f32_32x32x16_bf16 v[176:191], v[212:215], v[116:119], v[176:191]
    ds_read_b128 v[212:215], v225 offset:41984
    v_mfma_f32_32x32x16_bf16 v[160:175], v[200:203], v[120:123], v[160:175]
    ds_read_b128 v[200:203], v226 offset:1024
    v_mfma_f32_32x32x16_bf16 v[176:191], v[216:219], v[120:123], v[176:191]
    ds_read_b128 v[216:219], v226 offset:41984
    v_mfma_f32_32x32x16_bf16 v[160:175], v[204:207], v[124:127], v[160:175]
    ds_read_b128 v[204:207], v227 offset:1024
    v_mfma_f32_32x32x16_bf16 v[176:191], v[220:223], v[124:127], v[176:191]
    ds_read_b128 v[220:223], v227 offset:41984
    s_waitcnt lgkmcnt(8)
    s_barrier
    ds_read_b64_tr_b16 v[144:145], v237 offset:16384
    ds_read_b64_tr_b16 v[146:147], v237 offset:17408
    ds_read_b64_tr_b16 v[148:149], v237 offset:20480
    ds_read_b64_tr_b16 v[150:151], v237 offset:21504
    ds_read_b64_tr_b16 v[152:153], v237 offset:24576
    ds_read_b64_tr_b16 v[154:155], v237 offset:25600
    ds_read_b64_tr_b16 v[156:157], v237 offset:28672
    ds_read_b64_tr_b16 v[158:159], v237 offset:29696
    s_waitcnt lgkmcnt(8)
    v_dot2c_f32_bf16 v238, v239, v128
    v_dot2c_f32_bf16 v238, v239, v129
    v_dot2c_f32_bf16 v238, v239, v130
    v_dot2c_f32_bf16 v238, v239, v131
    v_dot2c_f32_bf16 v238, v239, v132
    v_dot2c_f32_bf16 v238, v239, v133
    v_dot2c_f32_bf16 v238, v239, v134
    v_dot2c_f32_bf16 v238, v239, v135
    v_dot2c_f32_bf16 v238, v239, v136
    v_dot2c_f32_bf16 v238, v239, v137
    v_dot2c_f32_bf16 v238, v239, v138
    v_dot2c_f32_bf16 v238, v239, v139
    v_dot2c_f32_bf16 v238, v239, v140
    v_dot2c_f32_bf16 v238, v239, v141
    v_dot2c_f32_bf16 v238, v239, v142
    v_dot2c_f32_bf16 v238, v239, v143
    v_mfma_f32_32x32x16_bf16 v[160:175], v[192:195], v[128:131], v[160:175]
    ds_read_b128 v[192:195], v228 offset:1024
    v_mfma_f32_32x32x16_bf16 v[176:191], v[208:211], v[128:131], v[176:191]
    ds_read_b128 v[208:211], v228 offset:41984
    v_mfma_f32_32x32x16_bf16 v[160:175], v[196:199], v[132:135], v[160:175]
    ds_read_b128 v[196:199], v229 offset:1024
    v_mfma_f32_32x32x16_bf16 v[176:191], v[212:215], v[132:135], v[176:191]
    ds_read_b128 v[212:215], v229 offset:41984
    v_mfma_f32_32x32x16_bf16 v[160:175], v[200:203], v[136:139], v[160:175]
    ds_read_b128 v[200:203], v230 offset:1024
    v_mfma_f32_32x32x16_bf16 v[176:191], v[216:219], v[136:139], v[176:191]
    ds_read_b128 v[216:219], v230 offset:41984
    v_mfma_f32_32x32x16_bf16 v[160:175], v[204:207], v[140:143], v[160:175]
    ds_read_b128 v[204:207], v231 offset:1024
    v_mfma_f32_32x32x16_bf16 v[176:191], v[220:223], v[140:143], v[176:191]
    ds_read_b128 v[220:223], v231 offset:41984
    s_waitcnt lgkmcnt(8)
    s_waitcnt lgkmcnt(0)
    v_dot2c_f32_bf16 v238, v239, v144
    v_dot2c_f32_bf16 v238, v239, v145
    v_dot2c_f32_bf16 v238, v239, v146
    v_dot2c_f32_bf16 v238, v239, v147
    v_dot2c_f32_bf16 v238, v239, v148
    v_dot2c_f32_bf16 v238, v239, v149
    v_dot2c_f32_bf16 v238, v239, v150
    v_dot2c_f32_bf16 v238, v239, v151
    v_dot2c_f32_bf16 v238, v239, v152
    v_dot2c_f32_bf16 v238, v239, v153
    v_dot2c_f32_bf16 v238, v239, v154
    v_dot2c_f32_bf16 v238, v239, v155
    v_dot2c_f32_bf16 v238, v239, v156
    v_dot2c_f32_bf16 v238, v239, v157
    v_dot2c_f32_bf16 v238, v239, v158
    v_dot2c_f32_bf16 v238, v239, v159
    v_mfma_f32_32x32x16_bf16 v[160:175], v[192:195], v[144:147], v[160:175]
    v_mfma_f32_32x32x16_bf16 v[176:191], v[208:211], v[144:147], v[176:191]
    v_mfma_f32_32x32x16_bf16 v[160:175], v[196:199], v[148:151], v[160:175]
    v_mfma_f32_32x32x16_bf16 v[176:191], v[212:215], v[148:151], v[176:191]
    v_mfma_f32_32x32x16_bf16 v[160:175], v[200:203], v[152:155], v[160:175]
    v_mfma_f32_32x32x16_bf16 v[176:191], v[216:219], v[152:155], v[176:191]
    v_mfma_f32_32x32x16_bf16 v[160:175], v[204:207], v[156:159], v[160:175]
    v_mfma_f32_32x32x16_bf16 v[176:191], v[220:223], v[156:159], v[176:191]
    s_waitcnt lgkmcnt(0)
    s_barrier
    s_nop 2
    v_mov_b32 v240, v238
    s_nop 1
    v_permlane32_swap_b32 v238, v240
    s_nop 1
    v_add_f32 v238, v238, v240
    v_mov_b32 v255, v238
    s_waitcnt lgkmcnt(0)
    s_mov_b32 s61, s59
    s_nop 7
    s_nop 7
    ds_read_b128 v[244:247], v254 offset:0
    ds_read_b128 v[248:251], v254 offset:128
    s_waitcnt lgkmcnt(0)
    v_mul_f32 v236, v248, v255
    v_fma_f32 v236, v160, v244, -v236
    v_mul_f32 v237, v249, v255
    v_fma_f32 v237, v161, v245, -v237
    v_mul_f32 v238, v250, v255
    v_fma_f32 v238, v162, v246, -v238
    v_mul_f32 v239, v251, v255
    v_fma_f32 v239, v163, v247, -v239
    v_cvt_pk_bf16_f32 v240, v236, v237
    v_cvt_pk_bf16_f32 v241, v238, v239
    ds_read_b128 v[244:247], v254 offset:32
    ds_read_b128 v[248:251], v254 offset:160
    s_waitcnt lgkmcnt(0)
    v_mul_f32 v236, v248, v255
    v_fma_f32 v236, v164, v244, -v236
    v_mul_f32 v237, v249, v255
    v_fma_f32 v237, v165, v245, -v237
    v_mul_f32 v238, v250, v255
    v_fma_f32 v238, v166, v246, -v238
    v_mul_f32 v239, v251, v255
    v_fma_f32 v239, v167, v247, -v239
    v_cvt_pk_bf16_f32 v242, v236, v237
    v_cvt_pk_bf16_f32 v243, v238, v239
    s_nop 1
    v_permlane32_swap_b32 v240, v242
    v_permlane32_swap_b32 v241, v243
    buffer_store_dwordx4 v[240:243], v232, s[16:19], s61 offen offset:0
    ds_read_b128 v[244:247], v254 offset:64
    ds_read_b128 v[248:251], v254 offset:192
    s_waitcnt lgkmcnt(0)
    v_mul_f32 v236, v248, v255
    v_fma_f32 v236, v168, v244, -v236
    v_mul_f32 v237, v249, v255
    v_fma_f32 v237, v169, v245, -v237
    v_mul_f32 v238, v250, v255
    v_fma_f32 v238, v170, v246, -v238
    v_mul_f32 v239, v251, v255
    v_fma_f32 v239, v171, v247, -v239
    v_cvt_pk_bf16_f32 v240, v236, v237
    v_cvt_pk_bf16_f32 v241, v238, v239
    ds_read_b128 v[244:247], v254 offset:96
    ds_read_b128 v[248:251], v254 offset:224
    s_waitcnt lgkmcnt(0)
    v_mul_f32 v236, v248, v255
    v_fma_f32 v236, v172, v244, -v236
    v_mul_f32 v237, v249, v255
    v_fma_f32 v237, v173, v245, -v237
    v_mul_f32 v238, v250, v255
    v_fma_f32 v238, v174, v246, -v238
    v_mul_f32 v239, v251, v255
    v_fma_f32 v239, v175, v247, -v239
    v_cvt_pk_bf16_f32 v242, v236, v237
    v_cvt_pk_bf16_f32 v243, v238, v239
    s_nop 1
    v_permlane32_swap_b32 v240, v242
    v_permlane32_swap_b32 v241, v243
    buffer_store_dwordx4 v[240:243], v232, s[16:19], s61 offen offset:32
    v_add_u32 v254, 256, v254
    s_add_u32 s61, s61, s60
    s_mov_b32 s74, 81920
    v_add_u32 v224, s74, v224
    v_add_u32 v225, s74, v225
    v_add_u32 v226, s74, v226
    v_add_u32 v227, s74, v227
    v_add_u32 v228, s74, v228
    v_add_u32 v229, s74, v229
    v_add_u32 v230, s74, v230
    v_add_u32 v231, s74, v231
    s_mov_b32 s75, 4294885376
    s_mov_b32 s76, 40960
    s_mov_b32 s69, 2
    s_mov_b32 s70, 0
    s_waitcnt lgkmcnt(0)
    s_barrier
    ds_read_b128 v[192:195], v224 offset:0
    ds_read_b128 v[196:199], v225 offset:0
    ds_read_b128 v[200:203], v226 offset:0
    ds_read_b128 v[204:207], v227 offset:0
    ds_read_b128 v[208:211], v228 offset:0
    ds_read_b128 v[212:215], v229 offset:0
K1_LOOP_V:
    s_add_u32 s69, s69, 1
    s_cmp_ge_u32 s69, 3
    s_cselect_b32 s74, s75, s76
    s_cselect_b32 s69, 0, s69
    s_waitcnt lgkmcnt(5)
    v_mfma_f32_32x32x16_bf16 v[160:175], v[192:195], v[0:3], 0
    ds_read_b128 v[216:219], v230 offset:0
    s_waitcnt lgkmcnt(5)
    v_mfma_f32_32x32x16_bf16 v[160:175], v[196:199], v[4:7], v[160:175]
    ds_read_b128 v[220:223], v231 offset:0
    s_waitcnt lgkmcnt(5)
    v_mfma_f32_32x32x16_bf16 v[160:175], v[200:203], v[8:11], v[160:175]
    ds_read_b128 v[192:195], v224 offset:256
    ds_read_b128 v[244:247], v254 offset:0
    ds_read_b128 v[248:251], v254 offset:128
    s_waitcnt lgkmcnt(7)
    v_mfma_f32_32x32x16_bf16 v[160:175], v[204:207], v[12:15], v[160:175]
    ds_read_b128 v[196:199], v225 offset:256
    s_waitcnt lgkmcnt(7)
    v_mfma_f32_32x32x16_bf16 v[160:175], v[208:211], v[16:19], v[160:175]
    ds_read_b128 v[200:203], v226 offset:256
    s_waitcnt lgkmcnt(7)
    v_mfma_f32_32x32x16_bf16 v[160:175], v[212:215], v[20:23], v[160:175]
    ds_read_b128 v[204:207], v227 offset:256
    s_waitcnt lgkmcnt(7)
    v_mfma_f32_32x32x16_bf16 v[160:175], v[216:219], v[24:27], v[160:175]
    ds_read_b128 v[208:211], v228 offset:256
    s_waitcnt lgkmcnt(4)
    v_mul_f32 v236, v248, v255
    v_fma_f32 v236, v176, v244, -v236
    v_mul_f32 v237, v249, v255
    v_fma_f32 v237, v177, v245, -v237
    v_mul_f32 v238, v250, v255
    v_fma_f32 v238, v178, v246, -v238
    v_mul_f32 v239, v251, v255
    v_fma_f32 v239, v179, v247, -v239
    v_mfma_f32_32x32x16_bf16 v[160:175], v[220:223], v[28:31], v[160:175]
    ds_read_b128 v[212:215], v229 offset:256
    v_mfma_f32_32x32x16_bf16 v[160:175], v[192:195], v[32:35], v[160:175]
    ds_read_b128 v[216:219], v230 offset:256
    v_cvt_pk_bf16_f32 v240, v236, v237
    v_cvt_pk_bf16_f32 v241, v238, v239
    s_waitcnt lgkmcnt(5)
    v_mfma_f32_32x32x16_bf16 v[160:175], v[196:199], v[36:39], v[160:175]
    ds_read_b128 v[220:223], v231 offset:256
    ds_read_b128 v[244:247], v254 offset:32
    ds_read_b128 v[248:251], v254 offset:160
    s_waitcnt lgkmcnt(7)
    v_mfma_f32_32x32x16_bf16 v[160:175], v[200:203], v[40:43], v[160:175]
    ds_read_b128 v[192:195], v224 offset:512
    s_waitcnt lgkmcnt(7)
    v_mfma_f32_32x32x16_bf16 v[160:175], v[204:207], v[44:47], v[160:175]
    ds_read_b128 v[196:199], v225 offset:512
    s_waitcnt lgkmcnt(7)
    v_mfma_f32_32x32x16_bf16 v[160:175], v[208:211], v[48:51], v[160:175]
    ds_read_b128 v[200:203], v226 offset:512
    s_waitcnt lgkmcnt(7)
    v_mfma_f32_32x32x16_bf16 v[160:175], v[212:215], v[52:55], v[160:175]
    ds_read_b128 v[204:207], v227 offset:512
    s_waitcnt lgkmcnt(7)
    v_mfma_f32_32x32x16_bf16 v[160:175], v[216:219], v[56:59], v[160:175]
    ds_read_b128 v[208:211], v228 offset:512
    s_waitcnt lgkmcnt(5)
    v_mul_f32 v236, v248, v255
    v_fma_f32 v236, v180, v244, -v236
    v_mul_f32 v237, v249, v255
    v_fma_f32 v237, v181, v245, -v237
    v_mul_f32 v238, v250, v255
    v_fma_f32 v238, v182, v246, -v238
    v_mul_f32 v239, v251, v255
    v_fma_f32 v239, v183, v247, -v239
    v_mfma_f32_32x32x16_bf16 v[160:175], v[220:223], v[60:63], v[160:175]
    ds_read_b128 v[212:215], v229 offset:512
    v_cvt_pk_bf16_f32 v242, v236, v237
    v_cvt_pk_bf16_f32 v243, v238, v239
    s_nop 1
    v_permlane32_swap_b32 v240, v242
    v_permlane32_swap_b32 v241, v243
    buffer_store_dwordx4 v[240:243], v232, s[16:19], s61 offen offset:0
    s_waitcnt lgkmcnt(5)
    v_mfma_f32_32x32x16_bf16 v[160:175], v[192:195], v[64:67], v[160:175]
    ds_read_b128 v[216:219], v230 offset:512
    s_waitcnt lgkmcnt(5)
    v_mfma_f32_32x32x16_bf16 v[160:175], v[196:199], v[68:71], v[160:175]
    ds_read_b128 v[220:223], v231 offset:512
    ds_read_b128 v[244:247], v254 offset:64
    ds_read_b128 v[248:251], v254 offset:192
    s_waitcnt lgkmcnt(7)
    v_mfma_f32_32x32x16_bf16 v[160:175], v[200:203], v[72:75], v[160:175]
    ds_read_b128 v[192:195], v224 offset:768
    s_waitcnt lgkmcnt(7)
    v_mfma_f32_32x32x16_bf16 v[160:175], v[204:207], v[76:79], v[160:175]
    ds_read_b128 v[196:199], v225 offset:768
    s_waitcnt lgkmcnt(7)
    v_mfma_f32_32x32x16_bf16 v[160:175], v[208:211], v[80:83], v[160:175]
    ds_read_b128 v[200:203], v226 offset:768
    s_waitcnt lgkmcnt(7)
    v_mfma_f32_32x32x16_bf16 v[160:175], v[212:215], v[84:87], v[160:175]
    ds_read_b128 v[204:207], v227 offset:768
    s_waitcnt lgkmcnt(7)
    v_mfma_f32_32x32x16_bf16 v[160:175], v[216:219], v[88:91], v[160:175]
    ds_read_b128 v[208:211], v228 offset:768
    s_waitcnt lgkmcnt(5)
    v_mul_f32 v236, v248, v255
    v_fma_f32 v236, v184, v244, -v236
    v_mul_f32 v237, v249, v255
    v_fma_f32 v237, v185, v245, -v237
    v_mul_f32 v238, v250, v255
    v_fma_f32 v238, v186, v246, -v238
    v_mul_f32 v239, v251, v255
    v_fma_f32 v239, v187, v247, -v239
    v_mfma_f32_32x32x16_bf16 v[160:175], v[220:223], v[92:95], v[160:175]
    ds_read_b128 v[212:215], v229 offset:768
    v_cvt_pk_bf16_f32 v240, v236, v237
    v_cvt_pk_bf16_f32 v241, v238, v239
    s_waitcnt lgkmcnt(5)
    v_mfma_f32_32x32x16_bf16 v[160:175], v[192:195], v[96:99], v[160:175]
    ds_read_b128 v[216:219], v230 offset:768
    s_waitcnt lgkmcnt(5)
    v_mfma_f32_32x32x16_bf16 v[160:175], v[196:199], v[100:103], v[160:175]
    ds_read_b128 v[220:223], v231 offset:768
    ds_read_b128 v[244:247], v254 offset:96
    ds_read_b128 v[248:251], v254 offset:224
    s_waitcnt lgkmcnt(7)
    v_mfma_f32_32x32x16_bf16 v[160:175], v[200:203], v[104:107], v[160:175]
    ds_read_b128 v[192:195], v224 offset:1024
    s_waitcnt lgkmcnt(7)
    v_mfma_f32_32x32x16_bf16 v[160:175], v[204:207], v[108:111], v[160:175]
    ds_read_b128 v[196:199], v225 offset:1024
    s_waitcnt lgkmcnt(7)
    v_mfma_f32_32x32x16_bf16 v[160:175], v[208:211], v[112:115], v[160:175]
    ds_read_b128 v[200:203], v226 offset:1024
    s_waitcnt lgkmcnt(7)
    v_mfma_f32_32x32x16_bf16 v[160:175], v[212:215], v[116:119], v[160:175]
    ds_read_b128 v[204:207], v227 offset:1024
    s_waitcnt lgkmcnt(4)
    v_mul_f32 v236, v248, v255
    v_fma_f32 v236, v188, v244, -v236
    v_mul_f32 v237, v249, v255
    v_fma_f32 v237, v189, v245, -v237
    v_mul_f32 v238, v250, v255
    v_fma_f32 v238, v190, v246, -v238
    v_mul_f32 v239, v251, v255
    v_fma_f32 v239, v191, v247, -v239
    v_mfma_f32_32x32x16_bf16 v[160:175], v[216:219], v[120:123], v[160:175]
    ds_read_b128 v[208:211], v228 offset:1024
    v_mfma_f32_32x32x16_bf16 v[160:175], v[220:223], v[124:127], v[160:175]
    ds_read_b128 v[212:215], v229 offset:1024
    v_cvt_pk_bf16_f32 v242, v236, v237
    v_cvt_pk_bf16_f32 v243, v238, v239
    s_nop 1
    v_permlane32_swap_b32 v240, v242
    v_permlane32_swap_b32 v241, v243
    buffer_store_dwordx4 v[240:243], v232, s[16:19], s61 offen offset:32
    s_waitcnt lgkmcnt(5)
    v_mfma_f32_32x32x16_bf16 v[160:175], v[192:195], v[128:131], v[160:175]
    ds_read_b128 v[216:219], v230 offset:1024
    s_waitcnt lgkmcnt(5)
    v_mfma_f32_32x32x16_bf16 v[160:175], v[196:199], v[132:135], v[160:175]
    ds_read_b128 v[220:223], v231 offset:1024
    s_waitcnt lgkmcnt(5)
    v_mfma_f32_32x32x16_bf16 v[160:175], v[200:203], v[136:139], v[160:175]
    s_waitcnt lgkmcnt(4)
    v_mfma_f32_32x32x16_bf16 v[160:175], v[204:207], v[140:143], v[160:175]
    s_waitcnt lgkmcnt(0)
    s_barrier
    v_add_u32 v224, s74, v224
    v_add_u32 v225, s74, v225
    v_add_u32 v226, s74, v226
    v_add_u32 v227, s74, v227
    v_add_u32 v228, s74, v228
    v_add_u32 v229, s74, v229
    v_add_u32 v230, s74, v230
    v_add_u32 v231, s74, v231
    ds_read_b128 v[192:195], v224 offset:0
    ds_read_b128 v[196:199], v225 offset:0
    v_mfma_f32_32x32x16_bf16 v[160:175], v[208:211], v[144:147], v[160:175]
    ds_read_b128 v[200:203], v226 offset:0
    v_mfma_f32_32x32x16_bf16 v[160:175], v[212:215], v[148:151], v[160:175]
    ds_read_b128 v[204:207], v227 offset:0
    v_mfma_f32_32x32x16_bf16 v[160:175], v[216:219], v[152:155], v[160:175]
    ds_read_b128 v[208:211], v228 offset:0
    v_mfma_f32_32x32x16_bf16 v[160:175], v[220:223], v[156:159], v[160:175]
    ds_read_b128 v[212:215], v229 offset:0
    s_add_u32 s61, s61, s60
    v_add_u32 v254, 256, v254
    s_add_u32 s69, s69, 1
    s_cmp_ge_u32 s69, 3
    s_cselect_b32 s74, s75, s76
    s_cselect_b32 s69, 0, s69
    s_waitcnt lgkmcnt(5)
    v_mfma_f32_32x32x16_bf16 v[176:191], v[192:195], v[0:3], 0
    ds_read_b128 v[216:219], v230 offset:0
    s_waitcnt lgkmcnt(5)
    v_mfma_f32_32x32x16_bf16 v[176:191], v[196:199], v[4:7], v[176:191]
    ds_read_b128 v[220:223], v231 offset:0
    s_waitcnt lgkmcnt(5)
    v_mfma_f32_32x32x16_bf16 v[176:191], v[200:203], v[8:11], v[176:191]
    ds_read_b128 v[192:195], v224 offset:256
    ds_read_b128 v[244:247], v254 offset:0
    ds_read_b128 v[248:251], v254 offset:128
    s_waitcnt lgkmcnt(7)
    v_mfma_f32_32x32x16_bf16 v[176:191], v[204:207], v[12:15], v[176:191]
    ds_read_b128 v[196:199], v225 offset:256
    s_waitcnt lgkmcnt(7)
    v_mfma_f32_32x32x16_bf16 v[176:191], v[208:211], v[16:19], v[176:191]
    ds_read_b128 v[200:203], v226 offset:256
    s_waitcnt lgkmcnt(7)
    v_mfma_f32_32x32x16_bf16 v[176:191], v[212:215], v[20:23], v[176:191]
    ds_read_b128 v[204:207], v227 offset:256
    s_waitcnt lgkmcnt(7)
    v_mfma_f32_32x32x16_bf16 v[176:191], v[216:219], v[24:27], v[176:191]
    ds_read_b128 v[208:211], v228 offset:256
    s_waitcnt lgkmcnt(4)
    v_mul_f32 v236, v248, v255
    v_fma_f32 v236, v160, v244, -v236
    v_mul_f32 v237, v249, v255
    v_fma_f32 v237, v161, v245, -v237
    v_mul_f32 v238, v250, v255
    v_fma_f32 v238, v162, v246, -v238
    v_mul_f32 v239, v251, v255
    v_fma_f32 v239, v163, v247, -v239
    v_mfma_f32_32x32x16_bf16 v[176:191], v[220:223], v[28:31], v[176:191]
    ds_read_b128 v[212:215], v229 offset:256
    v_mfma_f32_32x32x16_bf16 v[176:191], v[192:195], v[32:35], v[176:191]
    ds_read_b128 v[216:219], v230 offset:256
    v_cvt_pk_bf16_f32 v240, v236, v237
    v_cvt_pk_bf16_f32 v241, v238, v239
    s_waitcnt lgkmcnt(5)
    v_mfma_f32_32x32x16_bf16 v[176:191], v[196:199], v[36:39], v[176:191]
    ds_read_b128 v[220:223], v231 offset:256
    ds_read_b128 v[244:247], v254 offset:32
    ds_read_b128 v[248:251], v254 offset:160
    s_waitcnt lgkmcnt(7)
    v_mfma_f32_32x32x16_bf16 v[176:191], v[200:203], v[40:43], v[176:191]
    ds_read_b128 v[192:195], v224 offset:512
    s_waitcnt lgkmcnt(7)
    v_mfma_f32_32x32x16_bf16 v[176:191], v[204:207], v[44:47], v[176:191]
    ds_read_b128 v[196:199], v225 offset:512
    s_waitcnt lgkmcnt(7)
    v_mfma_f32_32x32x16_bf16 v[176:191], v[208:211], v[48:51], v[176:191]
    ds_read_b128 v[200:203], v226 offset:512
    s_waitcnt lgkmcnt(7)
    v_mfma_f32_32x32x16_bf16 v[176:191], v[212:215], v[52:55], v[176:191]
    ds_read_b128 v[204:207], v227 offset:512
    s_waitcnt lgkmcnt(7)
    v_mfma_f32_32x32x16_bf16 v[176:191], v[216:219], v[56:59], v[176:191]
    ds_read_b128 v[208:211], v228 offset:512
    s_waitcnt lgkmcnt(5)
    v_mul_f32 v236, v248, v255
    v_fma_f32 v236, v164, v244, -v236
    v_mul_f32 v237, v249, v255
    v_fma_f32 v237, v165, v245, -v237
    v_mul_f32 v238, v250, v255
    v_fma_f32 v238, v166, v246, -v238
    v_mul_f32 v239, v251, v255
    v_fma_f32 v239, v167, v247, -v239
    v_mfma_f32_32x32x16_bf16 v[176:191], v[220:223], v[60:63], v[176:191]
    ds_read_b128 v[212:215], v229 offset:512
    v_cvt_pk_bf16_f32 v242, v236, v237
    v_cvt_pk_bf16_f32 v243, v238, v239
    s_nop 1
    v_permlane32_swap_b32 v240, v242
    v_permlane32_swap_b32 v241, v243
    buffer_store_dwordx4 v[240:243], v232, s[16:19], s61 offen offset:0
    s_waitcnt lgkmcnt(5)
    v_mfma_f32_32x32x16_bf16 v[176:191], v[192:195], v[64:67], v[176:191]
    ds_read_b128 v[216:219], v230 offset:512
    s_waitcnt lgkmcnt(5)
    v_mfma_f32_32x32x16_bf16 v[176:191], v[196:199], v[68:71], v[176:191]
    ds_read_b128 v[220:223], v231 offset:512
    ds_read_b128 v[244:247], v254 offset:64
    ds_read_b128 v[248:251], v254 offset:192
    s_waitcnt lgkmcnt(7)
    v_mfma_f32_32x32x16_bf16 v[176:191], v[200:203], v[72:75], v[176:191]
    ds_read_b128 v[192:195], v224 offset:768
    s_waitcnt lgkmcnt(7)
    v_mfma_f32_32x32x16_bf16 v[176:191], v[204:207], v[76:79], v[176:191]
    ds_read_b128 v[196:199], v225 offset:768
    s_waitcnt lgkmcnt(7)
    v_mfma_f32_32x32x16_bf16 v[176:191], v[208:211], v[80:83], v[176:191]
    ds_read_b128 v[200:203], v226 offset:768
    s_waitcnt lgkmcnt(7)
    v_mfma_f32_32x32x16_bf16 v[176:191], v[212:215], v[84:87], v[176:191]
    ds_read_b128 v[204:207], v227 offset:768
    s_waitcnt lgkmcnt(7)
    v_mfma_f32_32x32x16_bf16 v[176:191], v[216:219], v[88:91], v[176:191]
    ds_read_b128 v[208:211], v228 offset:768
    s_waitcnt lgkmcnt(5)
    v_mul_f32 v236, v248, v255
    v_fma_f32 v236, v168, v244, -v236
    v_mul_f32 v237, v249, v255
    v_fma_f32 v237, v169, v245, -v237
    v_mul_f32 v238, v250, v255
    v_fma_f32 v238, v170, v246, -v238
    v_mul_f32 v239, v251, v255
    v_fma_f32 v239, v171, v247, -v239
    v_mfma_f32_32x32x16_bf16 v[176:191], v[220:223], v[92:95], v[176:191]
    ds_read_b128 v[212:215], v229 offset:768
    v_cvt_pk_bf16_f32 v240, v236, v237
    v_cvt_pk_bf16_f32 v241, v238, v239
    s_waitcnt lgkmcnt(5)
    v_mfma_f32_32x32x16_bf16 v[176:191], v[192:195], v[96:99], v[176:191]
    ds_read_b128 v[216:219], v230 offset:768
    s_waitcnt lgkmcnt(5)
    v_mfma_f32_32x32x16_bf16 v[176:191], v[196:199], v[100:103], v[176:191]
    ds_read_b128 v[220:223], v231 offset:768
    ds_read_b128 v[244:247], v254 offset:96
    ds_read_b128 v[248:251], v254 offset:224
    s_waitcnt lgkmcnt(7)
    v_mfma_f32_32x32x16_bf16 v[176:191], v[200:203], v[104:107], v[176:191]
    ds_read_b128 v[192:195], v224 offset:1024
    s_waitcnt lgkmcnt(7)
    v_mfma_f32_32x32x16_bf16 v[176:191], v[204:207], v[108:111], v[176:191]
    ds_read_b128 v[196:199], v225 offset:1024
    s_waitcnt lgkmcnt(7)
    v_mfma_f32_32x32x16_bf16 v[176:191], v[208:211], v[112:115], v[176:191]
    ds_read_b128 v[200:203], v226 offset:1024
    s_waitcnt lgkmcnt(7)
    v_mfma_f32_32x32x16_bf16 v[176:191], v[212:215], v[116:119], v[176:191]
    ds_read_b128 v[204:207], v227 offset:1024
    s_waitcnt lgkmcnt(4)
    v_mul_f32 v236, v248, v255
    v_fma_f32 v236, v172, v244, -v236
    v_mul_f32 v237, v249, v255
    v_fma_f32 v237, v173, v245, -v237
    v_mul_f32 v238, v250, v255
    v_fma_f32 v238, v174, v246, -v238
    v_mul_f32 v239, v251, v255
    v_fma_f32 v239, v175, v247, -v239
    v_mfma_f32_32x32x16_bf16 v[176:191], v[216:219], v[120:123], v[176:191]
    ds_read_b128 v[208:211], v228 offset:1024
    v_mfma_f32_32x32x16_bf16 v[176:191], v[220:223], v[124:127], v[176:191]
    ds_read_b128 v[212:215], v229 offset:1024
    v_cvt_pk_bf16_f32 v242, v236, v237
    v_cvt_pk_bf16_f32 v243, v238, v239
    s_nop 1
    v_permlane32_swap_b32 v240, v242
    v_permlane32_swap_b32 v241, v243
    buffer_store_dwordx4 v[240:243], v232, s[16:19], s61 offen offset:32
    s_waitcnt lgkmcnt(5)
    v_mfma_f32_32x32x16_bf16 v[176:191], v[192:195], v[128:131], v[176:191]
    ds_read_b128 v[216:219], v230 offset:1024
    s_waitcnt lgkmcnt(5)
    v_mfma_f32_32x32x16_bf16 v[176:191], v[196:199], v[132:135], v[176:191]
    ds_read_b128 v[220:223], v231 offset:1024
    s_waitcnt lgkmcnt(5)
    v_mfma_f32_32x32x16_bf16 v[176:191], v[200:203], v[136:139], v[176:191]
    s_waitcnt lgkmcnt(4)
    v_mfma_f32_32x32x16_bf16 v[176:191], v[204:207], v[140:143], v[176:191]
    s_waitcnt lgkmcnt(0)
    s_cmp_eq_u32 s70, 2
    s_cbranch_scc1 K1_LOOP_V_nb
    s_barrier
K1_LOOP_V_nb:
    v_add_u32 v224, s74, v224
    v_add_u32 v225, s74, v225
    v_add_u32 v226, s74, v226
    v_add_u32 v227, s74, v227
    v_add_u32 v228, s74, v228
    v_add_u32 v229, s74, v229
    v_add_u32 v230, s74, v230
    v_add_u32 v231, s74, v231
    ds_read_b128 v[192:195], v224 offset:0
    ds_read_b128 v[196:199], v225 offset:0
    v_mfma_f32_32x32x16_bf16 v[176:191], v[208:211], v[144:147], v[176:191]
    ds_read_b128 v[200:203], v226 offset:0
    v_mfma_f32_32x32x16_bf16 v[176:191], v[212:215], v[148:151], v[176:191]
    ds_read_b128 v[204:207], v227 offset:0
    v_mfma_f32_32x32x16_bf16 v[176:191], v[216:219], v[152:155], v[176:191]
    ds_read_b128 v[208:211], v228 offset:0
    v_mfma_f32_32x32x16_bf16 v[176:191], v[220:223], v[156:159], v[176:191]
    ds_read_b128 v[212:215], v229 offset:0
    s_add_u32 s61, s61, s60
    v_add_u32 v254, 256, v254
    s_add_u32 s70, s70, 1
    s_cmp_lt_u32 s70, 3
    s_cbranch_scc1 K1_LOOP_V
    s_waitcnt lgkmcnt(0)
    s_nop 7
    s_nop 7
    ds_read_b128 v[244:247], v254 offset:0
    ds_read_b128 v[248:251], v254 offset:128
    s_waitcnt lgkmcnt(0)
    v_mul_f32 v236, v248, v255
    v_fma_f32 v236, v176, v244, -v236
    v_mul_f32 v237, v249, v255
    v_fma_f32 v237, v177, v245, -v237
    v_mul_f32 v238, v250, v255
    v_fma_f32 v238, v178, v246, -v238
    v_mul_f32 v239, v251, v255
    v_fma_f32 v239, v179, v247, -v239
    v_cvt_pk_bf16_f32 v240, v236, v237
    v_cvt_pk_bf16_f32 v241, v238, v239
    ds_read_b128 v[244:247], v254 offset:32
    ds_read_b128 v[248:251], v254 offset:160
    s_waitcnt lgkmcnt(0)
    v_mul_f32 v236, v248, v255
    v_fma_f32 v236, v180, v244, -v236
    v_mul_f32 v237, v249, v255
    v_fma_f32 v237, v181, v245, -v237
    v_mul_f32 v238, v250, v255
    v_fma_f32 v238, v182, v246, -v238
    v_mul_f32 v239, v251, v255
    v_fma_f32 v239, v183, v247, -v239
    v_cvt_pk_bf16_f32 v242, v236, v237
    v_cvt_pk_bf16_f32 v243, v238, v239
    s_nop 1
    v_permlane32_swap_b32 v240, v242
    v_permlane32_swap_b32 v241, v243
    buffer_store_dwordx4 v[240:243], v232, s[16:19], s61 offen offset:0
    ds_read_b128 v[244:247], v254 offset:64
    ds_read_b128 v[248:251], v254 offset:192
    s_waitcnt lgkmcnt(0)
    v_mul_f32 v236, v248, v255
    v_fma_f32 v236, v184, v244, -v236
    v_mul_f32 v237, v249, v255
    v_fma_f32 v237, v185, v245, -v237
    v_mul_f32 v238, v250, v255
    v_fma_f32 v238, v186, v246, -v238
    v_mul_f32 v239, v251, v255
    v_fma_f32 v239, v187, v247, -v239
    v_cvt_pk_bf16_f32 v240, v236, v237
    v_cvt_pk_bf16_f32 v241, v238, v239
    ds_read_b128 v[244:247], v254 offset:96
    ds_read_b128 v[248:251], v254 offset:224
    s_waitcnt lgkmcnt(0)
    v_mul_f32 v236, v248, v255
    v_fma_f32 v236, v188, v244, -v236
    v_mul_f32 v237, v249, v255
    v_fma_f32 v237, v189, v245, -v237
    v_mul_f32 v238, v250, v255
    v_fma_f32 v238, v190, v246, -v238
    v_mul_f32 v239, v251, v255
    v_fma_f32 v239, v191, v247, -v239
    v_cvt_pk_bf16_f32 v242, v236, v237
    v_cvt_pk_bf16_f32 v243, v238, v239
    s_nop 1
    v_permlane32_swap_b32 v240, v242
    v_permlane32_swap_b32 v241, v243
    buffer_store_dwordx4 v[240:243], v232, s[16:19], s61 offen offset:32
    s_endpgm
K1_LOAD:
    s_cmp_lt_u32 s38, 15
    s_cbranch_scc0 K1_W1
    s_mov_b32 s8, s6
    s_and_b32 s9, s7, 0xffff
    s_mov_b32 s10, 0x258000
    s_mov_b32 s11, 0x00020000
    s_mov_b32 s42, 3840
    s_lshl_b32 s43, s38, 8
    s_branch K1_WD
K1_W1:
    s_mov_b32 s8, s24
    s_and_b32 s9, s25, 0xffff
    s_mov_b32 s10, 0x1e0000
    s_mov_b32 s11, 0x00020000
    s_mov_b32 s42, 3072
    s_sub_u32 s43, s38, 15
    s_lshl_b32 s43, s43, 8
K1_WD:
    v_lshrrev_b32 v1, 4, v243
    v_bfe_u32 v2, v243, 2, 2
    v_xor_b32 v2, v2, v1
    v_and_b32 v3, 3, v243
    v_lshl_or_b32 v2, v2, 2, v3
    v_lshlrev_b32 v2, 4, v2
    v_mul_lo_u32 v1, v1, s42
    v_add_u32 v210, v1, v2
    s_lshl_b32 s44, s41, 4
    s_mul_i32 s44, s44, s42
    s_add_u32 s44, s44, s43
    s_lshl_b32 s45, s41, 12
    s_lshl_b32 s46, s42, 2
    s_lshl_b32 s47, s42, 6
    s_mov_b32 s56, s81
    s_mov_b32 s58, s81
    s_lshl_b32 s86, s58, 7
    s_add_u32 s58, s58, 1
    s_cmp_eq_u32 s58, 10
    s_cselect_b32 s58, 0, s58
    s_lshl_b32 s87, s58, 7
    s_add_u32 s58, s58, 1
    s_cmp_eq_u32 s58, 10
    s_cselect_b32 s58, 0, s58
    s_lshl_b32 s88, s58, 7
    s_add_u32 s58, s58, 1
    s_cmp_eq_u32 s58, 10
    s_cselect_b32 s58, 0, s58
    s_lshl_b32 s89, s58, 7
    s_add_u32 s58, s58, 1
    s_cmp_eq_u32 s58, 10
    s_cselect_b32 s58, 0, s58
    s_lshl_b32 s90, s58, 7
    s_add_u32 s58, s58, 1
    s_cmp_eq_u32 s58, 10
    s_cselect_b32 s58, 0, s58
    s_lshl_b32 s91, s58, 7
    s_add_u32 s58, s58, 1
    s_cmp_eq_u32 s58, 10
    s_cselect_b32 s58, 0, s58
    s_lshl_b32 s92, s58, 7
    s_add_u32 s58, s58, 1
    s_cmp_eq_u32 s58, 10
    s_cselect_b32 s58, 0, s58
    s_lshl_b32 s93, s58, 7
    s_add_u32 s58, s58, 1
    s_cmp_eq_u32 s58, 10
    s_cselect_b32 s58, 0, s58
    s_lshl_b32 s94, s58, 7
    s_add_u32 s58, s58, 1
    s_cmp_eq_u32 s58, 10
    s_cselect_b32 s58, 0, s58
    s_lshl_b32 s95, s58, 7
    s_add_u32 s58, s58, 1
    s_cmp_eq_u32 s58, 10
    s_cselect_b32 s58, 0, s58
    v_lshrrev_b32 v161, 3, v243
    v_add_u32 v161, s79, v161
    v_and_b32 v162, 7, v243
    v_and_b32 v163, 15, v161
    v_mul_u32_u24 v164, 1280, v161
    v_lshl_add_u32 v200, v162, 4, v164
    v_xor_b32 v165, v162, v163
    v_lshl_add_u32 v203, v165, 4, v164
    v_add_u32 v165, 8, v162
    v_xor_b32 v165, v165, v163
    v_lshl_add_u32 v204, v165, 4, v164
    v_add_u32 v205, 40960, v203
    v_add_u32 v206, 40960, v204
    v_add_u32 v207, 81920, v203
    v_add_u32 v208, 81920, v204
    v_lshlrev_b32 v213, 2, v161
    v_add_u32 v213, 155648, v213
    v_lshlrev_b32 v201, 4, v243
    v_add_u32 v201, s45, v201
    v_add_u32 v202, 81920, v201
    v_add_u32 v201, 122880, v201
    v_mov_b32 v216, 0x3f803f80
    s_add_u32 s54, s49, 40960
    s_mul_i32 s57, s47, s56
    s_add_u32 s57, s57, s44
    buffer_load_dwordx4 v[0:3], v210, s[8:11], s57 offen
    s_add_u32 s57, s57, s46
    buffer_load_dwordx4 v[4:7], v210, s[8:11], s57 offen
    s_add_u32 s57, s57, s46
    buffer_load_dwordx4 v[8:11], v210, s[8:11], s57 offen
    s_add_u32 s57, s57, s46
    buffer_load_dwordx4 v[12:15], v210, s[8:11], s57 offen
    s_add_u32 s56, s56, 1
    s_cmp_eq_u32 s56, 10
    s_cselect_b32 s56, 0, s56
    s_add_u32 s57, s86, s49
    buffer_load_dwordx4 v[160:163], v200, s[12:15], s57 offen
    s_add_u32 s57, s86, s54
    buffer_load_dwordx4 v[164:167], v200, s[12:15], s57 offen
    s_mul_i32 s57, s47, s56
    s_add_u32 s57, s57, s44
    buffer_load_dwordx4 v[16:19], v210, s[8:11], s57 offen
    s_add_u32 s57, s57, s46
    buffer_load_dwordx4 v[20:23], v210, s[8:11], s57 offen
    s_add_u32 s57, s57, s46
    buffer_load_dwordx4 v[24:27], v210, s[8:11], s57 offen
    s_add_u32 s57, s57, s46
    buffer_load_dwordx4 v[28:31], v210, s[8:11], s57 offen
    s_add_u32 s56, s56, 1
    s_cmp_eq_u32 s56, 10
    s_cselect_b32 s56, 0, s56
    s_add_u32 s57, s87, s49
    buffer_load_dwordx4 v[168:171], v200, s[12:15], s57 offen
    s_add_u32 s57, s87, s54
    buffer_load_dwordx4 v[172:175], v200, s[12:15], s57 offen
    s_mul_i32 s57, s47, s56
    s_add_u32 s57, s57, s44
    buffer_load_dwordx4 v[32:35], v210, s[8:11], s57 offen
    s_add_u32 s57, s57, s46
    buffer_load_dwordx4 v[36:39], v210, s[8:11], s57 offen
    s_add_u32 s57, s57, s46
    buffer_load_dwordx4 v[40:43], v210, s[8:11], s57 offen
    s_add_u32 s57, s57, s46
    buffer_load_dwordx4 v[44:47], v210, s[8:11], s57 offen
    s_add_u32 s56, s56, 1
    s_cmp_eq_u32 s56, 10
    s_cselect_b32 s56, 0, s56
    s_add_u32 s57, s88, s49
    buffer_load_dwordx4 v[176:179], v200, s[12:15], s57 offen
    s_add_u32 s57, s88, s54
    buffer_load_dwordx4 v[180:183], v200, s[12:15], s57 offen
    s_mul_i32 s57, s47, s56
    s_add_u32 s57, s57, s44
    buffer_load_dwordx4 v[48:51], v210, s[8:11], s57 offen
    s_add_u32 s57, s57, s46
    buffer_load_dwordx4 v[52:55], v210, s[8:11], s57 offen
    s_add_u32 s57, s57, s46
    buffer_load_dwordx4 v[56:59], v210, s[8:11], s57 offen
    s_add_u32 s57, s57, s46
    buffer_load_dwordx4 v[60:63], v210, s[8:11], s57 offen
    s_add_u32 s56, s56, 1
    s_cmp_eq_u32 s56, 10
    s_cselect_b32 s56, 0, s56
    s_add_u32 s57, s89, s49
    buffer_load_dwordx4 v[184:187], v200, s[12:15], s57 offen
    s_add_u32 s57, s89, s54
    buffer_load_dwordx4 v[188:191], v200, s[12:15], s57 offen
    s_mov_b32 s71, 0x3acccccd
    s_mov_b32 s72, 0x3727c5ac
    s_waitcnt vmcnt(18)
    ds_write_b128 v201, v[0:3] offset:0
    ds_write_b128 v201, v[4:7] offset:1024
    ds_write_b128 v201, v[8:11] offset:2048
    ds_write_b128 v201, v[12:15] offset:3072
    ds_write_b128 v203, v[160:163] offset:0
    ds_write_b128 v205, v[164:167] offset:0
    s_waitcnt lgkmcnt(0)
    s_barrier
    s_mul_i32 s57, s47, s56
    s_add_u32 s57, s57, s44
    buffer_load_dwordx4 v[64:67], v210, s[8:11], s57 offen
    s_add_u32 s57, s57, s46
    buffer_load_dwordx4 v[68:71], v210, s[8:11], s57 offen
    s_add_u32 s57, s57, s46
    buffer_load_dwordx4 v[72:75], v210, s[8:11], s57 offen
    s_add_u32 s57, s57, s46
    buffer_load_dwordx4 v[76:79], v210, s[8:11], s57 offen
    s_add_u32 s56, s56, 1
    s_cmp_eq_u32 s56, 10
    s_cselect_b32 s56, 0, s56
    s_add_u32 s57, s90, s49
    buffer_load_dwordx4 v[192:195], v200, s[12:15], s57 offen
    s_add_u32 s57, s90, s54
    buffer_load_dwordx4 v[196:199], v200, s[12:15], s57 offen
    s_waitcnt vmcnt(18)
    ds_write_b128 v201, v[16:19] offset:16384
    ds_write_b128 v201, v[20:23] offset:17408
    ds_write_b128 v201, v[24:27] offset:18432
    ds_write_b128 v201, v[28:31] offset:19456
    ds_write_b128 v204, v[168:171] offset:0
    ds_write_b128 v206, v[172:175] offset:0
    s_waitcnt lgkmcnt(0)
    s_barrier
    s_mul_i32 s57, s47, s56
    s_add_u32 s57, s57, s44
    buffer_load_dwordx4 v[80:83], v210, s[8:11], s57 offen
    s_add_u32 s57, s57, s46
    buffer_load_dwordx4 v[84:87], v210, s[8:11], s57 offen
    s_add_u32 s57, s57, s46
    buffer_load_dwordx4 v[88:91], v210, s[8:11], s57 offen
    s_add_u32 s57, s57, s46
    buffer_load_dwordx4 v[92:95], v210, s[8:11], s57 offen
    s_add_u32 s56, s56, 1
    s_cmp_eq_u32 s56, 10
    s_cselect_b32 s56, 0, s56
    s_add_u32 s57, s91, s49
    buffer_load_dwordx4 v[160:163], v200, s[12:15], s57 offen
    s_add_u32 s57, s91, s54
    buffer_load_dwordx4 v[164:167], v200, s[12:15], s57 offen
    s_waitcnt vmcnt(18)
    ds_write_b128 v202, v[32:35] offset:0
    ds_write_b128 v202, v[36:39] offset:1024
    ds_write_b128 v202, v[40:43] offset:2048
    ds_write_b128 v202, v[44:47] offset:3072
    ds_write_b128 v203, v[176:179] offset:256
    ds_write_b128 v205, v[180:183] offset:256
    s_waitcnt lgkmcnt(0)
    s_barrier
    s_mul_i32 s57, s47, s56
    s_add_u32 s57, s57, s44
    buffer_load_dwordx4 v[96:99], v210, s[8:11], s57 offen
    s_add_u32 s57, s57, s46
    buffer_load_dwordx4 v[100:103], v210, s[8:11], s57 offen
    s_add_u32 s57, s57, s46
    buffer_load_dwordx4 v[104:107], v210, s[8:11], s57 offen
    s_add_u32 s57, s57, s46
    buffer_load_dwordx4 v[108:111], v210, s[8:11], s57 offen
    s_add_u32 s56, s56, 1
    s_cmp_eq_u32 s56, 10
    s_cselect_b32 s56, 0, s56
    s_add_u32 s57, s92, s49
    buffer_load_dwordx4 v[168:171], v200, s[12:15], s57 offen
    s_add_u32 s57, s92, s54
    buffer_load_dwordx4 v[172:175], v200, s[12:15], s57 offen
    s_waitcnt vmcnt(18)
    ds_write_b128 v202, v[48:51] offset:16384
    ds_write_b128 v202, v[52:55] offset:17408
    ds_write_b128 v202, v[56:59] offset:18432
    ds_write_b128 v202, v[60:63] offset:19456
    ds_write_b128 v204, v[184:187] offset:256
    ds_write_b128 v206, v[188:191] offset:256
    s_waitcnt lgkmcnt(0)
    s_barrier
    s_mul_i32 s57, s47, s56
    s_add_u32 s57, s57, s44
    buffer_load_dwordx4 v[112:115], v210, s[8:11], s57 offen
    s_add_u32 s57, s57, s46
    buffer_load_dwordx4 v[116:119], v210, s[8:11], s57 offen
    s_add_u32 s57, s57, s46
    buffer_load_dwordx4 v[120:123], v210, s[8:11], s57 offen
    s_add_u32 s57, s57, s46
    buffer_load_dwordx4 v[124:127], v210, s[8:11], s57 offen
    s_add_u32 s56, s56, 1
    s_cmp_eq_u32 s56, 10
    s_cselect_b32 s56, 0, s56
    s_add_u32 s57, s93, s49
    buffer_load_dwordx4 v[176:179], v200, s[12:15], s57 offen
    s_add_u32 s57, s93, s54
    buffer_load_dwordx4 v[180:183], v200, s[12:15], s57 offen
    s_waitcnt vmcnt(18)
    ds_write_b128 v201, v[64:67] offset:0
    ds_write_b128 v201, v[68:71] offset:1024
    ds_write_b128 v201, v[72:75] offset:2048
    ds_write_b128 v201, v[76:79] offset:3072
    ds_write_b128 v203, v[192:195] offset:512
    ds_write_b128 v205, v[196:199] offset:512
    s_waitcnt lgkmcnt(0)
    s_barrier
    v_mov_b32 v217, 0
    global_load_dword v218, v217, s[82:83] offset:252 sc1
    s_mul_i32 s57, s47, s56
    s_add_u32 s57, s57, s44
    buffer_load_dwordx4 v[128:131], v210, s[8:11], s57 offen
    s_add_u32 s57, s57, s46
    buffer_load_dwordx4 v[132:135], v210, s[8:11], s57 offen
    s_add_u32 s57, s57, s46
    buffer_load_dwordx4 v[136:139], v210, s[8:11], s57 offen
    s_add_u32 s57, s57, s46
    buffer_load_dwordx4 v[140:143], v210, s[8:11], s57 offen
    s_add_u32 s56, s56, 1
    s_cmp_eq_u32 s56, 10
    s_cselect_b32 s56, 0, s56
    s_add_u32 s57, s94, s49
    buffer_load_dwordx4 v[184:187], v200, s[12:15], s57 offen
    s_add_u32 s57, s94, s54
    buffer_load_dwordx4 v[188:191], v200, s[12:15], s57 offen
    s_waitcnt vmcnt(19)
    ds_write_b128 v201, v[80:83] offset:16384
    ds_write_b128 v201, v[84:87] offset:17408
    ds_write_b128 v201, v[88:91] offset:18432
    ds_write_b128 v201, v[92:95] offset:19456
    ds_write_b128 v204, v[160:163] offset:512
    ds_write_b128 v206, v[164:167] offset:512
    s_waitcnt lgkmcnt(0)
    s_barrier
    s_mul_i32 s57, s47, s56
    s_add_u32 s57, s57, s44
    buffer_load_dwordx4 v[144:147], v210, s[8:11], s57 offen
    s_add_u32 s57, s57, s46
    buffer_load_dwordx4 v[148:151], v210, s[8:11], s57 offen
    s_add_u32 s57, s57, s46
    buffer_load_dwordx4 v[152:155], v210, s[8:11], s57 offen
    s_add_u32 s57, s57, s46
    buffer_load_dwordx4 v[156:159], v210, s[8:11], s57 offen
    s_add_u32 s56, s56, 1
    s_cmp_eq_u32 s56, 10
    s_cselect_b32 s56, 0, s56
    s_add_u32 s57, s95, s49
    buffer_load_dwordx4 v[192:195], v200, s[12:15], s57 offen
    s_add_u32 s57, s95, s54
    buffer_load_dwordx4 v[196:199], v200, s[12:15], s57 offen
    s_add_u32 s55, s49, 81920
    s_add_u32 s57, s55, s86
    buffer_load_dwordx4 v[0:3], v200, s[12:15], s57 offen
    s_add_u32 s57, s55, s87
    buffer_load_dwordx4 v[4:7], v200, s[12:15], s57 offen
    s_add_u32 s57, s55, s88
    buffer_load_dwordx4 v[8:11], v200, s[12:15], s57 offen
    s_add_u32 s57, s55, s89
    buffer_load_dwordx4 v[12:15], v200, s[12:15], s57 offen
    s_add_u32 s57, s55, s90
    buffer_load_dwordx4 v[16:19], v200, s[12:15], s57 offen
    s_add_u32 s57, s55, s91
    buffer_load_dwordx4 v[20:23], v200, s[12:15], s57 offen
    s_add_u32 s57, s55, s92
    buffer_load_dwordx4 v[24:27], v200, s[12:15], s57 offen
    s_add_u32 s57, s55, s93
    buffer_load_dwordx4 v[28:31], v200, s[12:15], s57 offen
    s_add_u32 s57, s55, s94
    buffer_load_dwordx4 v[32:35], v200, s[12:15], s57 offen
    s_add_u32 s57, s55, s95
    buffer_load_dwordx4 v[36:39], v200, s[12:15], s57 offen
    s_waitcnt vmcnt(29)
    ds_write_b128 v202, v[96:99] offset:0
    ds_write_b128 v202, v[100:103] offset:1024
    ds_write_b128 v202, v[104:107] offset:2048
    ds_write_b128 v202, v[108:111] offset:3072
    ds_write_b128 v203, v[168:171] offset:768
    ds_write_b128 v205, v[172:175] offset:768
    s_waitcnt lgkmcnt(0)
    s_barrier
    s_waitcnt vmcnt(23)
    ds_write_b128 v202, v[112:115] offset:16384
    ds_write_b128 v202, v[116:119] offset:17408
    ds_write_b128 v202, v[120:123] offset:18432
    ds_write_b128 v202, v[124:127] offset:19456
    ds_write_b128 v204, v[176:179] offset:768
    ds_write_b128 v206, v[180:183] offset:768
    s_waitcnt lgkmcnt(0)
    s_barrier
    s_waitcnt vmcnt(22)
    v_readfirstlane_b32 s59, v218
    s_lshl_b32 s51, s39, 8
    s_lshl_b32 s52, s41, 9
    s_add_u32 s51, s51, s52
    s_add_u32 s51, s51, 29360128
    v_lshlrev_b32 v217, 4, v243
    s_mov_b32 exec_hi, 0
    buffer_load_dwordx4 v[220:223], v217, s[16:19], s51 offen sc1
    s_mov_b64 exec, -1
    s_add_u32 s55, s49, 122880
    s_add_u32 s57, s55, s86
    buffer_load_dwordx4 v[40:43], v200, s[12:15], s57 offen
    s_add_u32 s57, s55, s87
    buffer_load_dwordx4 v[44:47], v200, s[12:15], s57 offen
    s_add_u32 s57, s55, s88
    buffer_load_dwordx4 v[48:51], v200, s[12:15], s57 offen
    s_add_u32 s57, s55, s89
    buffer_load_dwordx4 v[52:55], v200, s[12:15], s57 offen
    s_add_u32 s57, s55, s90
    buffer_load_dwordx4 v[56:59], v200, s[12:15], s57 offen
    s_add_u32 s57, s55, s91
    buffer_load_dwordx4 v[60:63], v200, s[12:15], s57 offen
    s_add_u32 s57, s55, s92
    buffer_load_dwordx4 v[64:67], v200, s[12:15], s57 offen
    s_add_u32 s57, s55, s93
    buffer_load_dwordx4 v[68:71], v200, s[12:15], s57 offen
    s_add_u32 s57, s55, s94
    buffer_load_dwordx4 v[72:75], v200, s[12:15], s57 offen
    s_add_u32 s57, s55, s95
    buffer_load_dwordx4 v[76:79], v200, s[12:15], s57 offen
    s_waitcnt vmcnt(27)
    ds_write_b128 v201, v[128:131] offset:0
    ds_write_b128 v201, v[132:135] offset:1024
    ds_write_b128 v201, v[136:139] offset:2048
    ds_write_b128 v201, v[140:143] offset:3072
    ds_write_b128 v203, v[184:187] offset:1024
    ds_write_b128 v205, v[188:191] offset:1024
    s_waitcnt lgkmcnt(0)
    s_barrier
    s_waitcnt vmcnt(21)
    ds_write_b128 v201, v[144:147] offset:16384
    ds_write_b128 v201, v[148:151] offset:17408
    ds_write_b128 v201, v[152:155] offset:18432
    ds_write_b128 v201, v[156:159] offset:19456
    ds_write_b128 v204, v[192:195] offset:1024
    ds_write_b128 v206, v[196:199] offset:1024
    s_waitcnt lgkmcnt(0)
    s_barrier
    s_waitcnt vmcnt(10)
    s_cmp_ge_u32 s59, 32
    s_cbranch_scc0 K1_NS
    s_add_u32 s52, s52, 155648
    v_add_u32 v217, s52, v217
    s_mov_b32 exec_hi, 0
    ds_write_b128 v217, v[220:223]
    s_mov_b64 exec, -1
    s_waitcnt lgkmcnt(0)
K1_NS:
    s_cmp_ge_u32 s59, 32
    s_cbranch_scc1 K1_GSD
    v_mov_b32 v160, 0
K1_POLL:
    global_load_dword v161, v160, s[82:83] offset:252 sc1
    s_waitcnt vmcnt(0)
    v_readfirstlane_b32 s51, v161
    s_cmp_ge_u32 s51, 32
    s_cbranch_scc1 K1_POLLD
    s_sleep 2
    s_branch K1_POLL
K1_POLLD:
    s_lshl_b32 s51, s39, 8
    s_lshl_b32 s52, s41, 9
    s_add_u32 s51, s51, s52
    s_add_u32 s51, s51, 29360128
    v_lshlrev_b32 v160, 4, v243
    s_mov_b32 exec_hi, 0
    buffer_load_dwordx4 v[164:167], v160, s[16:19], s51 offen sc1
    s_add_u32 s52, s52, 155648
    v_add_u32 v160, s52, v160
    s_waitcnt vmcnt(0)
    ds_write_b128 v160, v[164:167]
    s_mov_b64 exec, -1
    s_waitcnt lgkmcnt(0)
K1_GSD:
    s_barrier
    ds_write_b128 v207, v[0:3] offset:0
    ds_write_b128 v208, v[4:7] offset:0
    ds_write_b128 v207, v[8:11] offset:256
    ds_write_b128 v208, v[12:15] offset:256
    ds_write_b128 v207, v[16:19] offset:512
    ds_write_b128 v208, v[20:23] offset:512
    ds_write_b128 v207, v[24:27] offset:768
    ds_write_b128 v208, v[28:31] offset:768
    ds_write_b128 v207, v[32:35] offset:1024
    ds_write_b128 v208, v[36:39] offset:1024
    s_waitcnt lgkmcnt(0)
    s_barrier
    s_add_u32 s55, s49, 163840
    s_add_u32 s57, s55, s86
    buffer_load_dwordx4 v[80:83], v200, s[12:15], s57 offen
    s_add_u32 s57, s55, s87
    buffer_load_dwordx4 v[84:87], v200, s[12:15], s57 offen
    s_add_u32 s57, s55, s88
    buffer_load_dwordx4 v[88:91], v200, s[12:15], s57 offen
    s_add_u32 s57, s55, s89
    buffer_load_dwordx4 v[92:95], v200, s[12:15], s57 offen
    s_add_u32 s57, s55, s90
    buffer_load_dwordx4 v[96:99], v200, s[12:15], s57 offen
    s_add_u32 s57, s55, s91
    buffer_load_dwordx4 v[100:103], v200, s[12:15], s57 offen
    s_add_u32 s57, s55, s92
    buffer_load_dwordx4 v[104:107], v200, s[12:15], s57 offen
    s_add_u32 s57, s55, s93
    buffer_load_dwordx4 v[108:111], v200, s[12:15], s57 offen
    s_add_u32 s57, s55, s94
    buffer_load_dwordx4 v[112:115], v200, s[12:15], s57 offen
    s_add_u32 s57, s55, s95
    buffer_load_dwordx4 v[116:119], v200, s[12:15], s57 offen
    s_waitcnt vmcnt(10)
    ds_write_b128 v203, v[40:43] offset:0
    ds_write_b128 v204, v[44:47] offset:0
    ds_write_b128 v203, v[48:51] offset:256
    ds_write_b128 v204, v[52:55] offset:256
    ds_write_b128 v203, v[56:59] offset:512
    ds_write_b128 v204, v[60:63] offset:512
    ds_write_b128 v203, v[64:67] offset:768
    ds_write_b128 v204, v[68:71] offset:768
    ds_write_b128 v203, v[72:75] offset:1024
    ds_write_b128 v204, v[76:79] offset:1024
    s_waitcnt lgkmcnt(0)
    s_barrier
    s_add_u32 s55, s49, 204800
    s_add_u32 s57, s55, s86
    buffer_load_dwordx4 v[120:123], v200, s[12:15], s57 offen
    s_add_u32 s57, s55, s87
    buffer_load_dwordx4 v[124:127], v200, s[12:15], s57 offen
    s_add_u32 s57, s55, s88
    buffer_load_dwordx4 v[128:131], v200, s[12:15], s57 offen
    s_add_u32 s57, s55, s89
    buffer_load_dwordx4 v[132:135], v200, s[12:15], s57 offen
    s_add_u32 s57, s55, s90
    buffer_load_dwordx4 v[136:139], v200, s[12:15], s57 offen
    s_add_u32 s57, s55, s91
    buffer_load_dwordx4 v[140:143], v200, s[12:15], s57 offen
    s_add_u32 s57, s55, s92
    buffer_load_dwordx4 v[144:147], v200, s[12:15], s57 offen
    s_add_u32 s57, s55, s93
    buffer_load_dwordx4 v[148:151], v200, s[12:15], s57 offen
    s_add_u32 s57, s55, s94
    buffer_load_dwordx4 v[152:155], v200, s[12:15], s57 offen
    s_add_u32 s57, s55, s95
    buffer_load_dwordx4 v[156:159], v200, s[12:15], s57 offen
    s_waitcnt vmcnt(10)
    ds_write_b128 v205, v[80:83] offset:0
    ds_write_b128 v206, v[84:87] offset:0
    ds_write_b128 v205, v[88:91] offset:256
    ds_write_b128 v206, v[92:95] offset:256
    ds_write_b128 v205, v[96:99] offset:512
    ds_write_b128 v206, v[100:103] offset:512
    ds_write_b128 v205, v[104:107] offset:768
    ds_write_b128 v206, v[108:111] offset:768
    ds_write_b128 v205, v[112:115] offset:1024
    ds_write_b128 v206, v[116:119] offset:1024
    s_waitcnt lgkmcnt(0)
    s_barrier
    s_add_u32 s55, s49, 245760
    s_add_u32 s57, s55, s86
    buffer_load_dwordx4 v[0:3], v200, s[12:15], s57 offen
    s_add_u32 s57, s55, s87
    buffer_load_dwordx4 v[4:7], v200, s[12:15], s57 offen
    s_add_u32 s57, s55, s88
    buffer_load_dwordx4 v[8:11], v200, s[12:15], s57 offen
    s_add_u32 s57, s55, s89
    buffer_load_dwordx4 v[12:15], v200, s[12:15], s57 offen
    s_add_u32 s57, s55, s90
    buffer_load_dwordx4 v[16:19], v200, s[12:15], s57 offen
    s_add_u32 s57, s55, s91
    buffer_load_dwordx4 v[20:23], v200, s[12:15], s57 offen
    s_add_u32 s57, s55, s92
    buffer_load_dwordx4 v[24:27], v200, s[12:15], s57 offen
    s_add_u32 s57, s55, s93
    buffer_load_dwordx4 v[28:31], v200, s[12:15], s57 offen
    s_add_u32 s57, s55, s94
    buffer_load_dwordx4 v[32:35], v200, s[12:15], s57 offen
    s_add_u32 s57, s55, s95
    buffer_load_dwordx4 v[36:39], v200, s[12:15], s57 offen
    s_waitcnt vmcnt(10)
    ds_write_b128 v207, v[120:123] offset:0
    ds_write_b128 v208, v[124:127] offset:0
    ds_write_b128 v207, v[128:131] offset:256
    ds_write_b128 v208, v[132:135] offset:256
    ds_write_b128 v207, v[136:139] offset:512
    ds_write_b128 v208, v[140:143] offset:512
    ds_write_b128 v207, v[144:147] offset:768
    ds_write_b128 v208, v[148:151] offset:768
    ds_write_b128 v207, v[152:155] offset:1024
    ds_write_b128 v208, v[156:159] offset:1024
    s_waitcnt lgkmcnt(0)
    s_barrier
    s_add_u32 s55, s49, 286720
    s_add_u32 s57, s55, s86
    buffer_load_dwordx4 v[40:43], v200, s[12:15], s57 offen
    s_add_u32 s57, s55, s87
    buffer_load_dwordx4 v[44:47], v200, s[12:15], s57 offen
    s_add_u32 s57, s55, s88
    buffer_load_dwordx4 v[48:51], v200, s[12:15], s57 offen
    s_add_u32 s57, s55, s89
    buffer_load_dwordx4 v[52:55], v200, s[12:15], s57 offen
    s_add_u32 s57, s55, s90
    buffer_load_dwordx4 v[56:59], v200, s[12:15], s57 offen
    s_add_u32 s57, s55, s91
    buffer_load_dwordx4 v[60:63], v200, s[12:15], s57 offen
    s_add_u32 s57, s55, s92
    buffer_load_dwordx4 v[64:67], v200, s[12:15], s57 offen
    s_add_u32 s57, s55, s93
    buffer_load_dwordx4 v[68:71], v200, s[12:15], s57 offen
    s_add_u32 s57, s55, s94
    buffer_load_dwordx4 v[72:75], v200, s[12:15], s57 offen
    s_add_u32 s57, s55, s95
    buffer_load_dwordx4 v[76:79], v200, s[12:15], s57 offen
    s_waitcnt vmcnt(10)
    ds_write_b128 v203, v[0:3] offset:0
    ds_write_b128 v204, v[4:7] offset:0
    ds_write_b128 v203, v[8:11] offset:256
    ds_write_b128 v204, v[12:15] offset:256
    ds_write_b128 v203, v[16:19] offset:512
    ds_write_b128 v204, v[20:23] offset:512
    ds_write_b128 v203, v[24:27] offset:768
    ds_write_b128 v204, v[28:31] offset:768
    ds_write_b128 v203, v[32:35] offset:1024
    ds_write_b128 v204, v[36:39] offset:1024
    s_waitcnt lgkmcnt(0)
    s_barrier
    s_waitcnt vmcnt(0)
    ds_write_b128 v205, v[40:43] offset:0
    ds_write_b128 v206, v[44:47] offset:0
    ds_write_b128 v205, v[48:51] offset:256
    ds_write_b128 v206, v[52:55] offset:256
    ds_write_b128 v205, v[56:59] offset:512
    ds_write_b128 v206, v[60:63] offset:512
    ds_write_b128 v205, v[64:67] offset:768
    ds_write_b128 v206, v[68:71] offset:768
    ds_write_b128 v205, v[72:75] offset:1024
    ds_write_b128 v206, v[76:79] offset:1024
    s_waitcnt lgkmcnt(0)
    s_barrier
    s_endpgm
K1_HELP:
    s_mov_b32 s16, s30
    s_and_b32 s17, s31, 0xffff
    s_mov_b32 s18, 0x2000000
    s_mov_b32 s19, 0x00020000
    s_cmp_ge_u32 s80, 4
    s_cbranch_scc1 K1_H1
    s_mov_b32 s12, s4
    s_and_b32 s13, s5, 0xffff
    s_mov_b32 s14, 0x280000
    s_mov_b32 s15, 0x00020000
    s_lshl_b32 s51, s80, 3
    s_add_u32 s51, s51, s32
    s_lshl_b32 s51, s51, 6
    s_lshl_b32 s52, s78, 3
    s_add_u32 s51, s51, s52
    v_lshrrev_b32 v1, 3, v243
    v_add_u32 v1, s51, v1
    v_and_b32 v2, 7, v243
    v_mul_u32_u24 v3, 1280, v1
    v_lshl_add_u32 v3, v2, 4, v3
    buffer_load_dwordx4 v[8:11], v3, s[12:15], 0 offen offset:0
    buffer_load_dwordx4 v[12:15], v3, s[12:15], 0 offen offset:128
    buffer_load_dwordx4 v[16:19], v3, s[12:15], 0 offen offset:256
    buffer_load_dwordx4 v[20:23], v3, s[12:15], 0 offen offset:384
    buffer_load_dwordx4 v[24:27], v3, s[12:15], 0 offen offset:512
    buffer_load_dwordx4 v[28:31], v3, s[12:15], 0 offen offset:640
    buffer_load_dwordx4 v[32:35], v3, s[12:15], 0 offen offset:768
    buffer_load_dwordx4 v[36:39], v3, s[12:15], 0 offen offset:896
    buffer_load_dwordx4 v[40:43], v3, s[12:15], 0 offen offset:1024
    buffer_load_dwordx4 v[44:47], v3, s[12:15], 0 offen offset:1152
    v_mov_b32 v4, 0
    v_mov_b32 v5, 0
    v_mov_b32 v6, 0x3f803f80
    v_lshrrev_b32 v7, 5, v1
    v_lshlrev_b32 v7, 8, v7
    v_and_b32 v1, 31, v1
    v_lshl_add_u32 v7, v1, 2, v7
    s_mov_b32 s71, 0x3acccccd
    s_mov_b32 s72, 0x3727c5ac
    s_mov_b32 s73, 29360128
    s_waitcnt vmcnt(9)
    v_dot2c_f32_bf16 v4, v6, v8
    v_dot2c_f32_bf16 v5, v8, v8
    v_dot2c_f32_bf16 v4, v6, v9
    v_dot2c_f32_bf16 v5, v9, v9
    v_dot2c_f32_bf16 v4, v6, v10
    v_dot2c_f32_bf16 v5, v10, v10
    v_dot2c_f32_bf16 v4, v6, v11
    v_dot2c_f32_bf16 v5, v11, v11
    s_waitcnt vmcnt(8)
    v_dot2c_f32_bf16 v4, v6, v12
    v_dot2c_f32_bf16 v5, v12, v12
    v_dot2c_f32_bf16 v4, v6, v13
    v_dot2c_f32_bf16 v5, v13, v13
    v_dot2c_f32_bf16 v4, v6, v14
    v_dot2c_f32_bf16 v5, v14, v14
    v_dot2c_f32_bf16 v4, v6, v15
    v_dot2c_f32_bf16 v5, v15, v15
    s_waitcnt vmcnt(7)
    v_dot2c_f32_bf16 v4, v6, v16
    v_dot2c_f32_bf16 v5, v16, v16
    v_dot2c_f32_bf16 v4, v6, v17
    v_dot2c_f32_bf16 v5, v17, v17
    v_dot2c_f32_bf16 v4, v6, v18
    v_dot2c_f32_bf16 v5, v18, v18
    v_dot2c_f32_bf16 v4, v6, v19
    v_dot2c_f32_bf16 v5, v19, v19
    s_waitcnt vmcnt(6)
    v_dot2c_f32_bf16 v4, v6, v20
    v_dot2c_f32_bf16 v5, v20, v20
    v_dot2c_f32_bf16 v4, v6, v21
    v_dot2c_f32_bf16 v5, v21, v21
    v_dot2c_f32_bf16 v4, v6, v22
    v_dot2c_f32_bf16 v5, v22, v22
    v_dot2c_f32_bf16 v4, v6, v23
    v_dot2c_f32_bf16 v5, v23, v23
    s_waitcnt vmcnt(5)
    v_dot2c_f32_bf16 v4, v6, v24
    v_dot2c_f32_bf16 v5, v24, v24
    v_dot2c_f32_bf16 v4, v6, v25
    v_dot2c_f32_bf16 v5, v25, v25
    v_dot2c_f32_bf16 v4, v6, v26
    v_dot2c_f32_bf16 v5, v26, v26
    v_dot2c_f32_bf16 v4, v6, v27
    v_dot2c_f32_bf16 v5, v27, v27
    s_waitcnt vmcnt(4)
    v_dot2c_f32_bf16 v4, v6, v28
    v_dot2c_f32_bf16 v5, v28, v28
    v_dot2c_f32_bf16 v4, v6, v29
    v_dot2c_f32_bf16 v5, v29, v29
    v_dot2c_f32_bf16 v4, v6, v30
    v_dot2c_f32_bf16 v5, v30, v30
    v_dot2c_f32_bf16 v4, v6, v31
    v_dot2c_f32_bf16 v5, v31, v31
    s_waitcnt vmcnt(3)
    v_dot2c_f32_bf16 v4, v6, v32
    v_dot2c_f32_bf16 v5, v32, v32
    v_dot2c_f32_bf16 v4, v6, v33
    v_dot2c_f32_bf16 v5, v33, v33
    v_dot2c_f32_bf16 v4, v6, v34
    v_dot2c_f32_bf16 v5, v34, v34
    v_dot2c_f32_bf16 v4, v6, v35
    v_dot2c_f32_bf16 v5, v35, v35
    s_waitcnt vmcnt(2)
    v_dot2c_f32_bf16 v4, v6, v36
    v_dot2c_f32_bf16 v5, v36, v36
    v_dot2c_f32_bf16 v4, v6, v37
    v_dot2c_f32_bf16 v5, v37, v37
    v_dot2c_f32_bf16 v4, v6, v38
    v_dot2c_f32_bf16 v5, v38, v38
    v_dot2c_f32_bf16 v4, v6, v39
    v_dot2c_f32_bf16 v5, v39, v39
    s_waitcnt vmcnt(1)
    v_dot2c_f32_bf16 v4, v6, v40
    v_dot2c_f32_bf16 v5, v40, v40
    v_dot2c_f32_bf16 v4, v6, v41
    v_dot2c_f32_bf16 v5, v41, v41
    v_dot2c_f32_bf16 v4, v6, v42
    v_dot2c_f32_bf16 v5, v42, v42
    v_dot2c_f32_bf16 v4, v6, v43
    v_dot2c_f32_bf16 v5, v43, v43
    s_waitcnt vmcnt(0)
    v_dot2c_f32_bf16 v4, v6, v44
    v_dot2c_f32_bf16 v5, v44, v44
    v_dot2c_f32_bf16 v4, v6, v45
    v_dot2c_f32_bf16 v5, v45, v45
    v_dot2c_f32_bf16 v4, v6, v46
    v_dot2c_f32_bf16 v5, v46, v46
    v_dot2c_f32_bf16 v4, v6, v47
    v_dot2c_f32_bf16 v5, v47, v47
    s_nop 2
    v_add_f32_dpp v4, v4, v4 quad_perm:[1,0,3,2] row_mask:0xf bank_mask:0xf
    v_add_f32_dpp v5, v5, v5 quad_perm:[1,0,3,2] row_mask:0xf bank_mask:0xf
    s_nop 2
    v_add_f32_dpp v4, v4, v4 quad_perm:[2,3,0,1] row_mask:0xf bank_mask:0xf
    v_add_f32_dpp v5, v5, v5 quad_perm:[2,3,0,1] row_mask:0xf bank_mask:0xf
    s_nop 2
    v_add_f32_dpp v4, v4, v4 row_half_mirror row_mask:0xf bank_mask:0xf
    v_add_f32_dpp v5, v5, v5 row_half_mirror row_mask:0xf bank_mask:0xf
    v_mul_f32 v4, s71, v4
    v_mul_f32 v5, s71, v5
    v_fma_f32 v5, -v4, v4, v5
    v_add_f32 v5, s72, v5
    v_rsq_f32 v5, v5
    s_nop 0
    v_mul_f32 v4, v4, v5
    v_cmp_eq_u32 vcc, 0, v2
    s_and_saveexec_b64 s[74:75], vcc
    buffer_store_dword v5, v7, s[16:19], s73 offen sc1
    buffer_store_dword v4, v7, s[16:19], s73 offen offset:128 sc1
    s_mov_b64 exec, s[74:75]
    s_waitcnt vmcnt(0)
    s_barrier
    s_cmp_lg_u32 s78, 0
    s_cbranch_scc1 K1_H0
    v_mov_b32 v4, 1
    v_mov_b32 v5, 0
    s_mov_b64 exec, 1
    global_atomic_add v5, v4, s[82:83] offset:252 sc1
    s_mov_b64 exec, -1
K1_H0:
    s_cmp_lg_u32 s2, 0
    s_cbranch_scc1 K1_H1
    v_lshlrev_b32 v1, 8, v243
    v_mov_b32 v4, 0
    v_mov_b32 v5, 0
    v_mov_b32 v6, 0
    v_mov_b32 v7, 0
    s_mov_b32 s51, 0x1C10000
    buffer_store_dwordx4 v[4:7], v1, s[16:19], s51 offen
K1_H1:
    s_cmp_ge_u32 s32, 6
    s_cbranch_scc1 K1_H2
    s_lshl_b32 s40, s32, 2
    s_add_u32 s40, s40, s33
    s_sub_u32 s40, s40, 28
    s_branch K1_H3
K1_H2:
    s_sub_u32 s40, s32, 6
    s_lshl_b32 s40, s40, 3
    s_add_u32 s40, s40, s33
K1_H3:
    s_lshl_b32 s40, s40, 3
    s_add_u32 s40, s40, s78
    v_lshrrev_b32 v1, 4, v243
    v_mul_u32_u24 v1, 10240, v1
    v_and_b32 v2, 15, v243
    v_lshl_add_u32 v1, v2, 1, v1
    v_add_u32 v2, 5120, v1
    v_lshlrev_b32 v3, 4, v243
    v_mov_b32 v4, -1
    v_mov_b32 v5, -1
    v_mov_b32 v6, -1
    v_mov_b32 v7, -1
    s_lshl_b32 s51, s40, 13
    s_add_u32 s51, s51, 25165824
    s_add_u32 s52, s51, 4096
    buffer_store_dwordx4 v[4:7], v3, s[16:19], s51 offen offset:0
    buffer_store_dwordx4 v[4:7], v3, s[16:19], s51 offen offset:1024
    buffer_store_dwordx4 v[4:7], v3, s[16:19], s51 offen offset:2048
    buffer_store_dwordx4 v[4:7], v3, s[16:19], s51 offen offset:3072
    buffer_store_dwordx4 v[4:7], v3, s[16:19], s52 offen offset:0
    buffer_store_dwordx4 v[4:7], v3, s[16:19], s52 offen offset:1024
    buffer_store_dwordx4 v[4:7], v3, s[16:19], s52 offen offset:2048
    buffer_store_dwordx4 v[4:7], v3, s[16:19], s52 offen offset:3072
    s_mov_b32 s8, s28
    s_and_b32 s9, s29, 0xffff
    s_mov_b32 s10, 0x1e0000
    s_mov_b32 s11, 0x00020000
    s_add_u32 s44, s40, 0
    s_mul_i32 s51, s44, 1639
    s_lshr_b32 s51, s51, 16
    s_mul_i32 s52, s51, 40
    s_sub_u32 s52, s44, s52
    s_mul_i32 s51, s51, 40960
    s_lshl_b32 s52, s52, 5
    s_add_u32 s51, s51, s52
    buffer_load_ushort v40, v1, s[8:11], s51 offen offset:0
    buffer_load_ushort v41, v1, s[8:11], s51 offen offset:1280
    buffer_load_ushort v42, v1, s[8:11], s51 offen offset:2560
    buffer_load_ushort v43, v1, s[8:11], s51 offen offset:3840
    buffer_load_ushort v44, v2, s[8:11], s51 offen offset:0
    buffer_load_ushort v45, v2, s[8:11], s51 offen offset:1280
    buffer_load_ushort v46, v2, s[8:11], s51 offen offset:2560
    buffer_load_ushort v47, v2, s[8:11], s51 offen offset:3840
    s_add_u32 s45, s40, 320
    s_mul_i32 s51, s45, 1639
    s_lshr_b32 s51, s51, 16
    s_mul_i32 s52, s51, 40
    s_sub_u32 s52, s45, s52
    s_mul_i32 s51, s51, 40960
    s_lshl_b32 s52, s52, 5
    s_add_u32 s51, s51, s52
    buffer_load_ushort v48, v1, s[8:11], s51 offen offset:0
    buffer_load_ushort v49, v1, s[8:11], s51 offen offset:1280
    buffer_load_ushort v50, v1, s[8:11], s51 offen offset:2560
    buffer_load_ushort v51, v1, s[8:11], s51 offen offset:3840
    buffer_load_ushort v52, v2, s[8:11], s51 offen offset:0
    buffer_load_ushort v53, v2, s[8:11], s51 offen offset:1280
    buffer_load_ushort v54, v2, s[8:11], s51 offen offset:2560
    buffer_load_ushort v55, v2, s[8:11], s51 offen offset:3840
    s_add_u32 s46, s40, 640
    s_mul_i32 s51, s46, 1639
    s_lshr_b32 s51, s51, 16
    s_mul_i32 s52, s51, 40
    s_sub_u32 s52, s46, s52
    s_mul_i32 s51, s51, 40960
    s_lshl_b32 s52, s52, 5
    s_add_u32 s51, s51, s52
    buffer_load_ushort v56, v1, s[8:11], s51 offen offset:0
    buffer_load_ushort v57, v1, s[8:11], s51 offen offset:1280
    buffer_load_ushort v58, v1, s[8:11], s51 offen offset:2560
    buffer_load_ushort v59, v1, s[8:11], s51 offen offset:3840
    buffer_load_ushort v60, v2, s[8:11], s51 offen offset:0
    buffer_load_ushort v61, v2, s[8:11], s51 offen offset:1280
    buffer_load_ushort v62, v2, s[8:11], s51 offen offset:2560
    buffer_load_ushort v63, v2, s[8:11], s51 offen offset:3840
    s_add_u32 s47, s40, 960
    s_mul_i32 s51, s47, 1639
    s_lshr_b32 s51, s51, 16
    s_mul_i32 s52, s51, 40
    s_sub_u32 s52, s47, s52
    s_mul_i32 s51, s51, 40960
    s_lshl_b32 s52, s52, 5
    s_add_u32 s51, s51, s52
    buffer_load_ushort v64, v1, s[8:11], s51 offen offset:0
    buffer_load_ushort v65, v1, s[8:11], s51 offen offset:1280
    buffer_load_ushort v66, v1, s[8:11], s51 offen offset:2560
    buffer_load_ushort v67, v1, s[8:11], s51 offen offset:3840
    buffer_load_ushort v68, v2, s[8:11], s51 offen offset:0
    buffer_load_ushort v69, v2, s[8:11], s51 offen offset:1280
    buffer_load_ushort v70, v2, s[8:11], s51 offen offset:2560
    buffer_load_ushort v71, v2, s[8:11], s51 offen offset:3840
    s_add_u32 s48, s40, 1280
    s_mul_i32 s51, s48, 1639
    s_lshr_b32 s51, s51, 16
    s_mul_i32 s52, s51, 40
    s_sub_u32 s52, s48, s52
    s_mul_i32 s51, s51, 40960
    s_lshl_b32 s52, s52, 5
    s_add_u32 s51, s51, s52
    buffer_load_ushort v72, v1, s[8:11], s51 offen offset:0
    buffer_load_ushort v73, v1, s[8:11], s51 offen offset:1280
    buffer_load_ushort v74, v1, s[8:11], s51 offen offset:2560
    buffer_load_ushort v75, v1, s[8:11], s51 offen offset:3840
    buffer_load_ushort v76, v2, s[8:11], s51 offen offset:0
    buffer_load_ushort v77, v2, s[8:11], s51 offen offset:1280
    buffer_load_ushort v78, v2, s[8:11], s51 offen offset:2560
    buffer_load_ushort v79, v2, s[8:11], s51 offen offset:3840
    s_add_u32 s49, s40, 1600
    s_mul_i32 s51, s49, 1639
    s_lshr_b32 s51, s51, 16
    s_mul_i32 s52, s51, 40
    s_sub_u32 s52, s49, s52
    s_mul_i32 s51, s51, 40960
    s_lshl_b32 s52, s52, 5
    s_add_u32 s51, s51, s52
    buffer_load_ushort v80, v1, s[8:11], s51 offen offset:0
    buffer_load_ushort v81, v1, s[8:11], s51 offen offset:1280
    buffer_load_ushort v82, v1, s[8:11], s51 offen offset:2560
    buffer_load_ushort v83, v1, s[8:11], s51 offen offset:3840
    buffer_load_ushort v84, v2, s[8:11], s51 offen offset:0
    buffer_load_ushort v85, v2, s[8:11], s51 offen offset:1280
    buffer_load_ushort v86, v2, s[8:11], s51 offen offset:2560
    buffer_load_ushort v87, v2, s[8:11], s51 offen offset:3840
    s_waitcnt vmcnt(0)
    v_lshl_or_b32 v8, v41, 16, v40
    v_lshl_or_b32 v9, v43, 16, v42
    v_lshl_or_b32 v10, v45, 16, v44
    v_lshl_or_b32 v11, v47, 16, v46
    s_lshl_b32 s51, s44, 10
    s_add_u32 s51, s51, 20971520
    buffer_store_dwordx4 v[8:11], v3, s[16:19], s51 offen
    v_lshl_or_b32 v12, v49, 16, v48
    v_lshl_or_b32 v13, v51, 16, v50
    v_lshl_or_b32 v14, v53, 16, v52
    v_lshl_or_b32 v15, v55, 16, v54
    s_lshl_b32 s51, s45, 10
    s_add_u32 s51, s51, 20971520
    buffer_store_dwordx4 v[12:15], v3, s[16:19], s51 offen
    v_lshl_or_b32 v16, v57, 16, v56
    v_lshl_or_b32 v17, v59, 16, v58
    v_lshl_or_b32 v18, v61, 16, v60
    v_lshl_or_b32 v19, v63, 16, v62
    s_lshl_b32 s51, s46, 10
    s_add_u32 s51, s51, 20971520
    buffer_store_dwordx4 v[16:19], v3, s[16:19], s51 offen
    v_lshl_or_b32 v20, v65, 16, v64
    v_lshl_or_b32 v21, v67, 16, v66
    v_lshl_or_b32 v22, v69, 16, v68
    v_lshl_or_b32 v23, v71, 16, v70
    s_lshl_b32 s51, s47, 10
    s_add_u32 s51, s51, 20971520
    buffer_store_dwordx4 v[20:23], v3, s[16:19], s51 offen
    v_lshl_or_b32 v24, v73, 16, v72
    v_lshl_or_b32 v25, v75, 16, v74
    v_lshl_or_b32 v26, v77, 16, v76
    v_lshl_or_b32 v27, v79, 16, v78
    s_lshl_b32 s51, s48, 10
    s_add_u32 s51, s51, 20971520
    buffer_store_dwordx4 v[24:27], v3, s[16:19], s51 offen
    v_lshl_or_b32 v28, v81, 16, v80
    v_lshl_or_b32 v29, v83, 16, v82
    v_lshl_or_b32 v30, v85, 16, v84
    v_lshl_or_b32 v31, v87, 16, v86
    s_lshl_b32 s51, s49, 10
    s_add_u32 s51, s51, 20971520
    buffer_store_dwordx4 v[28:31], v3, s[16:19], s51 offen
    s_nop 1
    s_mov_b32 s8, s20
    s_and_b32 s9, s21, 0xffff
    s_mov_b32 s10, 0xc8000
    s_mov_b32 s11, 0x00020000
    s_add_u32 s44, s40, 0
    s_mul_i32 s51, s44, 1639
    s_lshr_b32 s51, s51, 16
    s_mul_i32 s52, s51, 40
    s_sub_u32 s52, s44, s52
    s_mul_i32 s51, s51, 40960
    s_lshl_b32 s52, s52, 5
    s_add_u32 s51, s51, s52
    buffer_load_ushort v40, v1, s[8:11], s51 offen offset:0
    buffer_load_ushort v41, v1, s[8:11], s51 offen offset:1280
    buffer_load_ushort v42, v1, s[8:11], s51 offen offset:2560
    buffer_load_ushort v43, v1, s[8:11], s51 offen offset:3840
    buffer_load_ushort v44, v2, s[8:11], s51 offen offset:0
    buffer_load_ushort v45, v2, s[8:11], s51 offen offset:1280
    buffer_load_ushort v46, v2, s[8:11], s51 offen offset:2560
    buffer_load_ushort v47, v2, s[8:11], s51 offen offset:3840
    s_add_u32 s45, s40, 320
    s_mul_i32 s51, s45, 1639
    s_lshr_b32 s51, s51, 16
    s_mul_i32 s52, s51, 40
    s_sub_u32 s52, s45, s52
    s_mul_i32 s51, s51, 40960
    s_lshl_b32 s52, s52, 5
    s_add_u32 s51, s51, s52
    buffer_load_ushort v48, v1, s[8:11], s51 offen offset:0
    buffer_load_ushort v49, v1, s[8:11], s51 offen offset:1280
    buffer_load_ushort v50, v1, s[8:11], s51 offen offset:2560
    buffer_load_ushort v51, v1, s[8:11], s51 offen offset:3840
    buffer_load_ushort v52, v2, s[8:11], s51 offen offset:0
    buffer_load_ushort v53, v2, s[8:11], s51 offen offset:1280
    buffer_load_ushort v54, v2, s[8:11], s51 offen offset:2560
    buffer_load_ushort v55, v2, s[8:11], s51 offen offset:3840
    s_add_u32 s46, s40, 640
    s_mul_i32 s51, s46, 1639
    s_lshr_b32 s51, s51, 16
    s_mul_i32 s52, s51, 40
    s_sub_u32 s52, s46, s52
    s_mul_i32 s51, s51, 40960
    s_lshl_b32 s52, s52, 5
    s_add_u32 s51, s51, s52
    buffer_load_ushort v56, v1, s[8:11], s51 offen offset:0
    buffer_load_ushort v57, v1, s[8:11], s51 offen offset:1280
    buffer_load_ushort v58, v1, s[8:11], s51 offen offset:2560
    buffer_load_ushort v59, v1, s[8:11], s51 offen offset:3840
    buffer_load_ushort v60, v2, s[8:11], s51 offen offset:0
    buffer_load_ushort v61, v2, s[8:11], s51 offen offset:1280
    buffer_load_ushort v62, v2, s[8:11], s51 offen offset:2560
    buffer_load_ushort v63, v2, s[8:11], s51 offen offset:3840
    s_waitcnt vmcnt(0)
    v_lshl_or_b32 v8, v41, 16, v40
    v_lshl_or_b32 v9, v43, 16, v42
    v_lshl_or_b32 v10, v45, 16, v44
    v_lshl_or_b32 v11, v47, 16, v46
    s_lshl_b32 s51, s44, 10
    s_add_u32 s51, s51, 23068672
    buffer_store_dwordx4 v[8:11], v3, s[16:19], s51 offen
    v_lshl_or_b32 v12, v49, 16, v48
    v_lshl_or_b32 v13, v51, 16, v50
    v_lshl_or_b32 v14, v53, 16, v52
    v_lshl_or_b32 v15, v55, 16, v54
    s_lshl_b32 s51, s45, 10
    s_add_u32 s51, s51, 23068672
    buffer_store_dwordx4 v[12:15], v3, s[16:19], s51 offen
    v_lshl_or_b32 v16, v57, 16, v56
    v_lshl_or_b32 v17, v59, 16, v58
    v_lshl_or_b32 v18, v61, 16, v60
    v_lshl_or_b32 v19, v63, 16, v62
    s_lshl_b32 s51, s46, 10
    s_add_u32 s51, s51, 23068672
    buffer_store_dwordx4 v[16:19], v3, s[16:19], s51 offen
    s_nop 1
K1_END:
    s_endpgm
.globl k23_kernel
.p2align 8
.type k23_kernel,@function
k23_kernel:
    s_cmp_ge_u32 s2, 256
    s_cbranch_scc1 K23_END
    s_load_dwordx2 s[4:5], s[0:1], 0
    s_load_dwordx4 s[24:27], s[0:1], 56
    s_load_dwordx4 s[28:31], s[0:1], 72
    v_lshrrev_b32 v1, 6, v0
    s_nop 0
    v_readfirstlane_b32 s33, v1
    s_and_b32 s36, s33, 3
    s_and_b32 s34, s2, 7
    s_lshl_b32 s34, s34, 2
    s_lshr_b32 s35, s2, 6
    s_add_u32 s34, s34, s35
    s_bfe_u32 s35, s2, 0x30003
    v_mov_b32 v1, 102400
    v_mov_b32 v2, 0
    v_mov_b32 v3, 0
    ds_write_b64 v1, v[2:3]
    ds_write_b64 v1, v[2:3] offset:8
    ds_write_b64 v1, v[2:3] offset:16
    ds_write_b64 v1, v[2:3] offset:24
    s_cmp_ge_u32 s33, 4
    s_cbranch_scc1 K23_F
    v_and_b32 v251, 63, v0
    s_lshl_b32 s35, s35, 2
    s_add_u32 s35, s35, s36
    s_waitcnt lgkmcnt(0)
    s_add_u32 s8, s30, 0x3fd800
    s_addc_u32 s9, s31, 0
    s_and_b32 s9, s9, 0xffff
    s_mov_b32 s10, 0x282800
    s_mov_b32 s11, 0x00020000
    s_add_u32 s12, s30, 0x7fd800
    s_addc_u32 s13, s31, 0
    s_and_b32 s13, s13, 0xffff
    s_mov_b32 s14, 0x282800
    s_mov_b32 s15, 0x00020000
    s_mov_b32 s16, s30
    s_and_b32 s17, s31, 0xffff
    s_mov_b32 s18, 0x2000000
    s_mov_b32 s19, 0x00020000
    s_setprio 3
    v_and_b32 v151, 15, v251
    v_lshrrev_b32 v152, 4, v251
    v_lshrrev_b32 v153, 2, v151
    v_and_b32 v154, 3, v151
    v_lshl_add_u32 v153, v153, 3, v154
    s_lshl_b32 s72, s35, 11
    s_lshl_b32 s73, s34, 6
    s_add_u32 s72, s72, s73
    s_mul_i32 s74, s72, 40
    v_mul_u32_u24 v153, 40, v153
    v_lshl_add_u32 v153, v152, 4, v153
    v_add_u32 v240, s74, v153
    v_mul_u32_u24 v153, 40, v151
    v_lshl_add_u32 v153, v152, 4, v153
    v_add_u32 v243, s74, v153
    s_mul_i32 s75, s35, 20
    s_mul_i32 s76, s35, 81920
    s_mul_i32 s77, s34, 2560
    s_add_u32 s76, s76, s77
    v_lshlrev_b32 v153, 6, v151
    v_lshl_add_u32 v153, v152, 4, v153
    v_add_u32 v241, s76, v153
    v_cmp_gt_u32 s[78:79], 4, v151
    buffer_load_dwordx4 v[216:219], v243, s[16:19], 0 offen offset:0
    buffer_load_dwordx4 v[220:223], v243, s[16:19], 0 offen offset:640
    buffer_load_dwordx4 v[224:227], v243, s[16:19], 0 offen offset:1280
    buffer_load_dwordx4 v[228:231], v243, s[16:19], 0 offen offset:1920
    s_movk_i32 s77, 0
    buffer_load_dwordx4 v[0:3], v240, s[8:11], s77 offen offset:0
    buffer_load_dwordx4 v[4:7], v240, s[8:11], s77 offen offset:160
    s_movk_i32 s77, 1280
    buffer_load_dwordx4 v[8:11], v240, s[8:11], s77 offen offset:0
    buffer_load_dwordx4 v[12:15], v240, s[8:11], s77 offen offset:160
    s_movk_i32 s77, 2560
    buffer_load_dwordx4 v[16:19], v240, s[8:11], s77 offen offset:0
    buffer_load_dwordx4 v[20:23], v240, s[8:11], s77 offen offset:160
    s_movk_i32 s77, 3840
    buffer_load_dwordx4 v[24:27], v240, s[8:11], s77 offen offset:0
    buffer_load_dwordx4 v[28:31], v240, s[8:11], s77 offen offset:160
    s_movk_i32 s77, 5120
    buffer_load_dwordx4 v[32:35], v240, s[8:11], s77 offen offset:0
    buffer_load_dwordx4 v[36:39], v240, s[8:11], s77 offen offset:160
    s_movk_i32 s77, 6400
    buffer_load_dwordx4 v[40:43], v240, s[8:11], s77 offen offset:0
    buffer_load_dwordx4 v[44:47], v240, s[8:11], s77 offen offset:160
    s_movk_i32 s77, 7680
    buffer_load_dwordx4 v[48:51], v240, s[8:11], s77 offen offset:0
    buffer_load_dwordx4 v[52:55], v240, s[8:11], s77 offen offset:160
    s_movk_i32 s77, 8960
    buffer_load_dwordx4 v[56:59], v240, s[8:11], s77 offen offset:0
    buffer_load_dwordx4 v[60:63], v240, s[8:11], s77 offen offset:160
    s_movk_i32 s77, 10240
    buffer_load_dwordx4 v[64:67], v240, s[8:11], s77 offen offset:0
    buffer_load_dwordx4 v[68:71], v240, s[8:11], s77 offen offset:160
    v_cmp_eq_u32 vcc, 4, v151
    v_mov_b32 v153, 0x3f803f80
    s_nop 0
    v_cndmask_b32 v153, 0, v153, vcc
    v_mov_b32 v76, v153
    v_mov_b32 v77, v153
    v_mov_b32 v78, v153
    v_mov_b32 v79, v153
    v_mov_b32 v84, v153
    v_mov_b32 v85, v153
    v_mov_b32 v86, v153
    v_mov_b32 v87, v153
    v_mov_b32 v92, v153
    v_mov_b32 v93, v153
    v_mov_b32 v94, v153
    v_mov_b32 v95, v153
    v_mov_b32 v100, v153
    v_mov_b32 v101, v153
    v_mov_b32 v102, v153
    v_mov_b32 v103, v153
    v_mov_b32 v108, v153
    v_mov_b32 v109, v153
    v_mov_b32 v110, v153
    v_mov_b32 v111, v153
    v_mov_b32 v116, v153
    v_mov_b32 v117, v153
    v_mov_b32 v118, v153
    v_mov_b32 v119, v153
    v_mov_b32 v124, v153
    v_mov_b32 v125, v153
    v_mov_b32 v126, v153
    v_mov_b32 v127, v153
    v_mov_b32 v132, v153
    v_mov_b32 v133, v153
    v_mov_b32 v134, v153
    v_mov_b32 v135, v153
    v_mov_b32 v140, v153
    v_mov_b32 v141, v153
    v_mov_b32 v142, v153
    v_mov_b32 v143, v153
    s_movk_i32 s77, 0
    buffer_load_dwordx4 v[72:75], v241, s[12:15], s77 offen
    s_mov_b64 exec, s[78:79]
    buffer_load_dwordx4 v[76:79], v241, s[12:15], s77 offen offset:1024
    s_mov_b64 exec, -1
    s_movk_i32 s77, 1280
    buffer_load_dwordx4 v[80:83], v241, s[12:15], s77 offen
    s_mov_b64 exec, s[78:79]
    buffer_load_dwordx4 v[84:87], v241, s[12:15], s77 offen offset:1024
    s_mov_b64 exec, -1
    s_movk_i32 s77, 2560
    buffer_load_dwordx4 v[88:91], v241, s[12:15], s77 offen
    s_mov_b64 exec, s[78:79]
    buffer_load_dwordx4 v[92:95], v241, s[12:15], s77 offen offset:1024
    s_mov_b64 exec, -1
    s_movk_i32 s77, 3840
    buffer_load_dwordx4 v[96:99], v241, s[12:15], s77 offen
    s_mov_b64 exec, s[78:79]
    buffer_load_dwordx4 v[100:103], v241, s[12:15], s77 offen offset:1024
    s_mov_b64 exec, -1
    s_movk_i32 s77, 5120
    buffer_load_dwordx4 v[104:107], v241, s[12:15], s77 offen
    s_mov_b64 exec, s[78:79]
    buffer_load_dwordx4 v[108:111], v241, s[12:15], s77 offen offset:1024
    s_mov_b64 exec, -1
    s_movk_i32 s77, 6400
    buffer_load_dwordx4 v[112:115], v241, s[12:15], s77 offen
    s_mov_b64 exec, s[78:79]
    buffer_load_dwordx4 v[116:119], v241, s[12:15], s77 offen offset:1024
    s_mov_b64 exec, -1
    s_movk_i32 s77, 7680
    buffer_load_dwordx4 v[120:123], v241, s[12:15], s77 offen
    s_mov_b64 exec, s[78:79]
    buffer_load_dwordx4 v[124:127], v241, s[12:15], s77 offen offset:1024
    s_mov_b64 exec, -1
    s_movk_i32 s77, 8960
    buffer_load_dwordx4 v[128:131], v241, s[12:15], s77 offen
    s_mov_b64 exec, s[78:79]
    buffer_load_dwordx4 v[132:135], v241, s[12:15], s77 offen offset:1024
    s_mov_b64 exec, -1
    s_movk_i32 s77, 10240
    buffer_load_dwordx4 v[136:139], v241, s[12:15], s77 offen
    s_mov_b64 exec, s[78:79]
    buffer_load_dwordx4 v[140:143], v241, s[12:15], s77 offen offset:1024
    s_mov_b64 exec, -1
    s_waitcnt lgkmcnt(0)
    s_barrier
    v_lshlrev_b32 v253, 3, v152
    v_mov_b32 v252, v151
    v_mov_b32 v246, 0xf149f2ca
    v_lshl_add_u32 v153, v152, 2, s75
    v_lshrrev_b32 v154, 5, v153
    v_lshlrev_b32 v154, 10, v154
    v_lshl_add_u32 v154, v151, 4, v154
    v_bfe_u32 v155, v153, 3, 2
    v_lshl_add_u32 v154, v155, 8, v154
    v_and_b32 v155, 4, v153
    v_lshl_add_u32 v244, v155, 1, v154
    s_add_u32 s80, s75, 16
    s_lshr_b32 s81, s80, 5
    s_lshl_b32 s81, s81, 10
    s_bfe_u32 s82, s80, 0x20003
    s_lshl_b32 s82, s82, 8
    s_add_u32 s81, s81, s82
    s_and_b32 s82, s80, 4
    s_lshl_b32 s82, s82, 1
    s_add_u32 s81, s81, s82
    v_lshl_add_u32 v245, v151, 4, s81
    v_add_u32 v250, 16, v151
    v_lshlrev_b32 v250, 2, v250
    s_mul_i32 s83, s34, 81920
    s_add_u32 s83, s83, 25165824
    v_cmp_gt_u32 s[84:85], 3, v152
    v_cmp_gt_u32 s[86:87], 2, v152
    v_cmp_eq_u32 s[88:89], 0, v152
    s_waitcnt vmcnt(36)
    v_cndmask_b32 v216, 0, v216, s[84:85]
    v_cndmask_b32 v217, 0, v217, s[84:85]
    v_cndmask_b32 v218, 0, v218, s[86:87]
    v_cndmask_b32 v219, 0, v219, s[86:87]
    v_cndmask_b32 v220, 0, v220, s[84:85]
    v_cndmask_b32 v221, 0, v221, s[84:85]
    v_cndmask_b32 v222, 0, v222, s[86:87]
    v_cndmask_b32 v223, 0, v223, s[86:87]
    v_cndmask_b32 v224, 0, v224, s[84:85]
    v_cndmask_b32 v225, 0, v225, s[84:85]
    v_cndmask_b32 v226, 0, v226, s[86:87]
    v_cndmask_b32 v227, 0, v227, s[86:87]
    v_cndmask_b32 v228, 0, v228, s[84:85]
    v_cndmask_b32 v229, 0, v229, s[84:85]
    v_cndmask_b32 v230, 0, v230, s[86:87]
    v_cndmask_b32 v231, 0, v231, s[86:87]
    s_lshl_b32 s90, s34, 1
    s_sub_i32 s90, 8, s90
    s_max_i32 s90, s90, 0
    s_waitcnt vmcnt(0)
    s_cmp_gt_u32 s90, 0
    s_cbranch_scc0 K2zv_1
    v_mov_b32 v72, 0
    v_mov_b32 v73, 0
    v_mov_b32 v74, 0
    v_mov_b32 v75, 0
    s_mov_b64 exec, s[78:79]
    v_mov_b32 v76, 0
    v_mov_b32 v77, 0
    v_mov_b32 v78, 0
    v_mov_b32 v79, 0
    s_mov_b64 exec, -1
K2zv_1:
    s_cmp_gt_u32 s90, 1
    s_cbranch_scc0 K2zv_2
    v_mov_b32 v80, 0
    v_mov_b32 v81, 0
    v_mov_b32 v82, 0
    v_mov_b32 v83, 0
    s_mov_b64 exec, s[78:79]
    v_mov_b32 v84, 0
    v_mov_b32 v85, 0
    v_mov_b32 v86, 0
    v_mov_b32 v87, 0
    s_mov_b64 exec, -1
K2zv_2:
    s_cmp_gt_u32 s90, 2
    s_cbranch_scc0 K2zv_3
    v_mov_b32 v88, 0
    v_mov_b32 v89, 0
    v_mov_b32 v90, 0
    v_mov_b32 v91, 0
    s_mov_b64 exec, s[78:79]
    v_mov_b32 v92, 0
    v_mov_b32 v93, 0
    v_mov_b32 v94, 0
    v_mov_b32 v95, 0
    s_mov_b64 exec, -1
K2zv_3:
    s_cmp_gt_u32 s90, 3
    s_cbranch_scc0 K2zv_4
    v_mov_b32 v96, 0
    v_mov_b32 v97, 0
    v_mov_b32 v98, 0
    v_mov_b32 v99, 0
    s_mov_b64 exec, s[78:79]
    v_mov_b32 v100, 0
    v_mov_b32 v101, 0
    v_mov_b32 v102, 0
    v_mov_b32 v103, 0
    s_mov_b64 exec, -1
K2zv_4:
    s_cmp_gt_u32 s90, 4
    s_cbranch_scc0 K2zv_5
    v_mov_b32 v104, 0
    v_mov_b32 v105, 0
    v_mov_b32 v106, 0
    v_mov_b32 v107, 0
    s_mov_b64 exec, s[78:79]
    v_mov_b32 v108, 0
    v_mov_b32 v109, 0
    v_mov_b32 v110, 0
    v_mov_b32 v111, 0
    s_mov_b64 exec, -1
K2zv_5:
    s_cmp_gt_u32 s90, 5
    s_cbranch_scc0 K2zv_6
    v_mov_b32 v112, 0
    v_mov_b32 v113, 0
    v_mov_b32 v114, 0
    v_mov_b32 v115, 0
    s_mov_b64 exec, s[78:79]
    v_mov_b32 v116, 0
    v_mov_b32 v117, 0
    v_mov_b32 v118, 0
    v_mov_b32 v119, 0
    s_mov_b64 exec, -1
K2zv_6:
    s_cmp_gt_u32 s90, 6
    s_cbranch_scc0 K2zv_7
    v_mov_b32 v120, 0
    v_mov_b32 v121, 0
    v_mov_b32 v122, 0
    v_mov_b32 v123, 0
    s_mov_b64 exec, s[78:79]
    v_mov_b32 v124, 0
    v_mov_b32 v125, 0
    v_mov_b32 v126, 0
    v_mov_b32 v127, 0
    s_mov_b64 exec, -1
K2zv_7:
    s_cmp_gt_u32 s90, 7
    s_cbranch_scc0 K2zv_8
    v_mov_b32 v128, 0
    v_mov_b32 v129, 0
    v_mov_b32 v130, 0
    v_mov_b32 v131, 0
    s_mov_b64 exec, s[78:79]
    v_mov_b32 v132, 0
    v_mov_b32 v133, 0
    v_mov_b32 v134, 0
    v_mov_b32 v135, 0
    s_mov_b64 exec, -1
K2zv_8:
    s_mov_b32 s92, 0
    s_mov_b32 s91, s83
K2_QB:
    v_mfma_f32_16x16x32_bf16 v[152:155], v[8:11], v[216:219], 0
    v_mfma_f32_16x16x32_bf16 v[156:159], v[12:15], v[216:219], 0
    v_mfma_f32_16x16x32_bf16 v[160:163], v[16:19], v[216:219], 0
    v_mfma_f32_16x16x32_bf16 v[164:167], v[20:23], v[216:219], 0
    v_mfma_f32_16x16x32_bf16 v[168:171], v[24:27], v[216:219], 0
    v_mfma_f32_16x16x32_bf16 v[172:175], v[28:31], v[216:219], 0
    v_mfma_f32_16x16x32_bf16 v[176:179], v[32:35], v[216:219], 0
    v_mfma_f32_16x16x32_bf16 v[180:183], v[36:39], v[216:219], 0
    v_mfma_f32_16x16x32_bf16 v[184:187], v[40:43], v[216:219], 0
    v_mfma_f32_16x16x32_bf16 v[188:191], v[44:47], v[216:219], 0
    v_mfma_f32_16x16x32_bf16 v[192:195], v[48:51], v[216:219], 0
    v_mfma_f32_16x16x32_bf16 v[196:199], v[52:55], v[216:219], 0
    v_mfma_f32_16x16x32_bf16 v[200:203], v[56:59], v[216:219], 0
    v_mfma_f32_16x16x32_bf16 v[204:207], v[60:63], v[216:219], 0
    v_mfma_f32_16x16x32_bf16 v[208:211], v[64:67], v[216:219], 0
    v_mfma_f32_16x16x32_bf16 v[212:215], v[68:71], v[216:219], 0
    s_waitcnt vmcnt(4)
    v_mfma_f32_16x16x32_bf16 v[144:147], v[0:3], v[216:219], 0
    v_mfma_f32_16x16x32_bf16 v[148:151], v[4:7], v[216:219], 0
    s_cmp_lg_u32 s92, 1
    s_cbranch_scc1 K2_QB_a
    s_movk_i32 s77, 11520
    buffer_load_dwordx4 v[0:3], v240, s[8:11], s77 offen offset:0
    buffer_load_dwordx4 v[4:7], v240, s[8:11], s77 offen offset:160
K2_QB_a:
    s_and_b32 s93, s92, 1
    s_lshl_b32 s93, s93, 4
    v_subrev_u32 v254, s93, v253
    v_cmp_le_i32 s[40:41], v254, v252
    v_add_u32 v254, 1, v254
    v_cmp_le_i32 s[42:43], v254, v252
    v_add_u32 v254, 1, v254
    v_cmp_le_i32 s[44:45], v254, v252
    v_add_u32 v254, 1, v254
    v_cmp_le_i32 s[46:47], v254, v252
    v_add_u32 v254, 1, v254
    v_cmp_le_i32 s[48:49], v254, v252
    v_add_u32 v254, 1, v254
    v_cmp_le_i32 s[50:51], v254, v252
    v_add_u32 v254, 1, v254
    v_cmp_le_i32 s[52:53], v254, v252
    v_add_u32 v254, 1, v254
    v_cmp_le_i32 s[54:55], v254, v252
    v_mov_b32 v216, v220
    v_mov_b32 v217, v221
    v_mov_b32 v218, v222
    v_mov_b32 v219, v223
    v_mov_b32 v220, v224
    v_mov_b32 v221, v225
    v_mov_b32 v222, v226
    v_mov_b32 v223, v227
    v_mov_b32 v224, v228
    v_mov_b32 v225, v229
    v_mov_b32 v226, v230
    v_mov_b32 v227, v231
    s_nop 3
    s_cmp_ge_u32 s92, 2
    s_cbranch_scc1 K2_QB_m2
    v_cndmask_b32 v144, v144, v246, s[40:41]
    v_cndmask_b32 v208, v246, v208, s[40:41]
    v_cndmask_b32 v145, v145, v246, s[42:43]
    v_cndmask_b32 v209, v246, v209, s[42:43]
    v_cndmask_b32 v146, v146, v246, s[44:45]
    v_cndmask_b32 v210, v246, v210, s[44:45]
    v_cndmask_b32 v147, v147, v246, s[46:47]
    v_cndmask_b32 v211, v246, v211, s[46:47]
    v_cndmask_b32 v148, v148, v246, s[48:49]
    v_cndmask_b32 v212, v246, v212, s[48:49]
    v_cndmask_b32 v149, v149, v246, s[50:51]
    v_cndmask_b32 v213, v246, v213, s[50:51]
    v_cndmask_b32 v150, v150, v246, s[52:53]
    v_cndmask_b32 v214, v246, v214, s[52:53]
    v_cndmask_b32 v151, v151, v246, s[54:55]
    v_cndmask_b32 v215, v246, v215, s[54:55]
    s_mov_b32 s93, 0
    s_branch K2_QB_m3
K2_QB_m2:
    v_cndmask_b32 v152, v152, v246, s[40:41]
    v_cndmask_b32 v144, v246, v144, s[40:41]
    v_cndmask_b32 v153, v153, v246, s[42:43]
    v_cndmask_b32 v145, v246, v145, s[42:43]
    v_cndmask_b32 v154, v154, v246, s[44:45]
    v_cndmask_b32 v146, v246, v146, s[44:45]
    v_cndmask_b32 v155, v155, v246, s[46:47]
    v_cndmask_b32 v147, v246, v147, s[46:47]
    v_cndmask_b32 v156, v156, v246, s[48:49]
    v_cndmask_b32 v148, v246, v148, s[48:49]
    v_cndmask_b32 v157, v157, v246, s[50:51]
    v_cndmask_b32 v149, v246, v149, s[50:51]
    v_cndmask_b32 v158, v158, v246, s[52:53]
    v_cndmask_b32 v150, v246, v150, s[52:53]
    v_cndmask_b32 v159, v159, v246, s[54:55]
    v_cndmask_b32 v151, v246, v151, s[54:55]
    s_mov_b32 s93, 9
K2_QB_m3:
    s_cmp_eq_u32 s90, 0
    s_cbranch_scc1 K2_QB_nv
    s_cmp_gt_u32 s90, s93
    s_cbranch_scc0 K2inv_9
    v_mov_b32 v144, v246
    v_mov_b32 v145, v246
    v_mov_b32 v146, v246
    v_mov_b32 v147, v246
    v_mov_b32 v148, v246
    v_mov_b32 v149, v246
    v_mov_b32 v150, v246
    v_mov_b32 v151, v246
K2inv_9:
    s_cmp_gt_u32 s90, 1
    s_cbranch_scc0 K2inv_10
    v_mov_b32 v152, v246
    v_mov_b32 v153, v246
    v_mov_b32 v154, v246
    v_mov_b32 v155, v246
    v_mov_b32 v156, v246
    v_mov_b32 v157, v246
    v_mov_b32 v158, v246
    v_mov_b32 v159, v246
K2inv_10:
    s_cmp_gt_u32 s90, 2
    s_cbranch_scc0 K2inv_11
    v_mov_b32 v160, v246
    v_mov_b32 v161, v246
    v_mov_b32 v162, v246
    v_mov_b32 v163, v246
    v_mov_b32 v164, v246
    v_mov_b32 v165, v246
    v_mov_b32 v166, v246
    v_mov_b32 v167, v246
K2inv_11:
    s_cmp_gt_u32 s90, 3
    s_cbranch_scc0 K2inv_12
    v_mov_b32 v168, v246
    v_mov_b32 v169, v246
    v_mov_b32 v170, v246
    v_mov_b32 v171, v246
    v_mov_b32 v172, v246
    v_mov_b32 v173, v246
    v_mov_b32 v174, v246
    v_mov_b32 v175, v246
K2inv_12:
    s_cmp_gt_u32 s90, 4
    s_cbranch_scc0 K2inv_13
    v_mov_b32 v176, v246
    v_mov_b32 v177, v246
    v_mov_b32 v178, v246
    v_mov_b32 v179, v246
    v_mov_b32 v180, v246
    v_mov_b32 v181, v246
    v_mov_b32 v182, v246
    v_mov_b32 v183, v246
K2inv_13:
    s_cmp_gt_u32 s90, 5
    s_cbranch_scc0 K2inv_14
    v_mov_b32 v184, v246
    v_mov_b32 v185, v246
    v_mov_b32 v186, v246
    v_mov_b32 v187, v246
    v_mov_b32 v188, v246
    v_mov_b32 v189, v246
    v_mov_b32 v190, v246
    v_mov_b32 v191, v246
K2inv_14:
    s_cmp_gt_u32 s90, 6
    s_cbranch_scc0 K2inv_15
    v_mov_b32 v192, v246
    v_mov_b32 v193, v246
    v_mov_b32 v194, v246
    v_mov_b32 v195, v246
    v_mov_b32 v196, v246
    v_mov_b32 v197, v246
    v_mov_b32 v198, v246
    v_mov_b32 v199, v246
K2inv_15:
    s_cmp_gt_u32 s90, 7
    s_cbranch_scc0 K2inv_16
    v_mov_b32 v200, v246
    v_mov_b32 v201, v246
    v_mov_b32 v202, v246
    v_mov_b32 v203, v246
    v_mov_b32 v204, v246
    v_mov_b32 v205, v246
    v_mov_b32 v206, v246
    v_mov_b32 v207, v246
K2inv_16:
K2_QB_nv:
    v_max3_f32 v247, v144, v145, v146
    v_max3_f32 v247, v247, v147, v148
    v_max3_f32 v247, v247, v149, v150
    v_max3_f32 v247, v247, v151, v152
    v_max3_f32 v247, v247, v153, v154
    v_max3_f32 v247, v247, v155, v156
    v_max3_f32 v247, v247, v157, v158
    v_max3_f32 v247, v247, v159, v160
    v_max3_f32 v247, v247, v161, v162
    v_max3_f32 v247, v247, v163, v164
    v_max3_f32 v247, v247, v165, v166
    v_max3_f32 v247, v247, v167, v168
    v_max3_f32 v247, v247, v169, v170
    v_max3_f32 v247, v247, v171, v172
    v_max3_f32 v247, v247, v173, v174
    v_max3_f32 v247, v247, v175, v176
    v_max3_f32 v247, v247, v177, v178
    v_max3_f32 v247, v247, v179, v180
    v_max3_f32 v247, v247, v181, v182
    v_max3_f32 v247, v247, v183, v184
    v_max3_f32 v247, v247, v185, v186
    v_max3_f32 v247, v247, v187, v188
    v_max3_f32 v247, v247, v189, v190
    v_max3_f32 v247, v247, v191, v192
    v_max3_f32 v247, v247, v193, v194
    v_max3_f32 v247, v247, v195, v196
    v_max3_f32 v247, v247, v197, v198
    v_max3_f32 v247, v247, v199, v200
    v_max3_f32 v247, v247, v201, v202
    v_max3_f32 v247, v247, v203, v204
    v_max3_f32 v247, v247, v205, v206
    v_max3_f32 v247, v247, v207, v208
    v_max3_f32 v247, v247, v209, v210
    v_max3_f32 v247, v247, v211, v212
    v_max3_f32 v247, v247, v213, v214
    v_max_f32 v247, v247, v215
    v_mov_b32 v248, v247
    s_nop 1
    v_permlane32_swap_b32 v247, v248
    s_nop 1
    v_max_f32 v247, v247, v248
    v_mov_b32 v248, v247
    s_nop 1
    v_permlane16_swap_b32 v247, v248
    s_nop 1
    v_max_f32 v247, v247, v248
    v_sub_f32 v152, v152, v247
    v_sub_f32 v153, v153, v247
    v_sub_f32 v154, v154, v247
    v_sub_f32 v155, v155, v247
    v_sub_f32 v156, v156, v247
    v_sub_f32 v157, v157, v247
    v_sub_f32 v158, v158, v247
    v_sub_f32 v159, v159, v247
    v_exp_f32 v152, v152
    v_exp_f32 v153, v153
    v_exp_f32 v154, v154
    v_exp_f32 v155, v155
    v_exp_f32 v156, v156
    v_exp_f32 v157, v157
    v_exp_f32 v158, v158
    v_exp_f32 v159, v159
    s_nop 0
    v_cvt_pk_bf16_f32 v152, v152, v153
    v_cvt_pk_bf16_f32 v153, v154, v155
    v_cvt_pk_bf16_f32 v154, v156, v157
    v_cvt_pk_bf16_f32 v155, v158, v159
    s_nop 1
    v_mfma_f32_16x16x32_bf16 v[232:235], v[80:83], v[152:155], 0
    v_mfma_f32_16x16x32_bf16 v[236:239], v[84:87], v[152:155], 0
    v_sub_f32 v160, v160, v247
    v_sub_f32 v161, v161, v247
    v_sub_f32 v162, v162, v247
    v_sub_f32 v163, v163, v247
    v_sub_f32 v164, v164, v247
    v_sub_f32 v165, v165, v247
    v_sub_f32 v166, v166, v247
    v_sub_f32 v167, v167, v247
    v_exp_f32 v160, v160
    v_exp_f32 v161, v161
    v_exp_f32 v162, v162
    v_exp_f32 v163, v163
    v_exp_f32 v164, v164
    v_exp_f32 v165, v165
    v_exp_f32 v166, v166
    v_exp_f32 v167, v167
    s_nop 0
    v_cvt_pk_bf16_f32 v160, v160, v161
    v_cvt_pk_bf16_f32 v161, v162, v163
    v_cvt_pk_bf16_f32 v162, v164, v165
    v_cvt_pk_bf16_f32 v163, v166, v167
    s_nop 1
    v_mfma_f32_16x16x32_bf16 v[232:235], v[88:91], v[160:163], v[232:235]
    v_mfma_f32_16x16x32_bf16 v[236:239], v[92:95], v[160:163], v[236:239]
    v_sub_f32 v168, v168, v247
    v_sub_f32 v169, v169, v247
    v_sub_f32 v170, v170, v247
    v_sub_f32 v171, v171, v247
    v_sub_f32 v172, v172, v247
    v_sub_f32 v173, v173, v247
    v_sub_f32 v174, v174, v247
    v_sub_f32 v175, v175, v247
    v_exp_f32 v168, v168
    v_exp_f32 v169, v169
    v_exp_f32 v170, v170
    v_exp_f32 v171, v171
    v_exp_f32 v172, v172
    v_exp_f32 v173, v173
    v_exp_f32 v174, v174
    v_exp_f32 v175, v175
    s_nop 0
    v_cvt_pk_bf16_f32 v168, v168, v169
    v_cvt_pk_bf16_f32 v169, v170, v171
    v_cvt_pk_bf16_f32 v170, v172, v173
    v_cvt_pk_bf16_f32 v171, v174, v175
    s_nop 1
    v_mfma_f32_16x16x32_bf16 v[232:235], v[96:99], v[168:171], v[232:235]
    v_mfma_f32_16x16x32_bf16 v[236:239], v[100:103], v[168:171], v[236:239]
    v_sub_f32 v176, v176, v247
    v_sub_f32 v177, v177, v247
    v_sub_f32 v178, v178, v247
    v_sub_f32 v179, v179, v247
    v_sub_f32 v180, v180, v247
    v_sub_f32 v181, v181, v247
    v_sub_f32 v182, v182, v247
    v_sub_f32 v183, v183, v247
    v_exp_f32 v176, v176
    v_exp_f32 v177, v177
    v_exp_f32 v178, v178
    v_exp_f32 v179, v179
    v_exp_f32 v180, v180
    v_exp_f32 v181, v181
    v_exp_f32 v182, v182
    v_exp_f32 v183, v183
    s_nop 0
    v_cvt_pk_bf16_f32 v176, v176, v177
    v_cvt_pk_bf16_f32 v177, v178, v179
    v_cvt_pk_bf16_f32 v178, v180, v181
    v_cvt_pk_bf16_f32 v179, v182, v183
    s_nop 1
    v_mfma_f32_16x16x32_bf16 v[232:235], v[104:107], v[176:179], v[232:235]
    v_mfma_f32_16x16x32_bf16 v[236:239], v[108:111], v[176:179], v[236:239]
    v_sub_f32 v184, v184, v247
    v_sub_f32 v185, v185, v247
    v_sub_f32 v186, v186, v247
    v_sub_f32 v187, v187, v247
    v_sub_f32 v188, v188, v247
    v_sub_f32 v189, v189, v247
    v_sub_f32 v190, v190, v247
    v_sub_f32 v191, v191, v247
    v_exp_f32 v184, v184
    v_exp_f32 v185, v185
    v_exp_f32 v186, v186
    v_exp_f32 v187, v187
    v_exp_f32 v188, v188
    v_exp_f32 v189, v189
    v_exp_f32 v190, v190
    v_exp_f32 v191, v191
    s_nop 0
    v_cvt_pk_bf16_f32 v184, v184, v185
    v_cvt_pk_bf16_f32 v185, v186, v187
    v_cvt_pk_bf16_f32 v186, v188, v189
    v_cvt_pk_bf16_f32 v187, v190, v191
    s_nop 1
    v_mfma_f32_16x16x32_bf16 v[232:235], v[112:115], v[184:187], v[232:235]
    v_mfma_f32_16x16x32_bf16 v[236:239], v[116:119], v[184:187], v[236:239]
    v_sub_f32 v192, v192, v247
    v_sub_f32 v193, v193, v247
    v_sub_f32 v194, v194, v247
    v_sub_f32 v195, v195, v247
    v_sub_f32 v196, v196, v247
    v_sub_f32 v197, v197, v247
    v_sub_f32 v198, v198, v247
    v_sub_f32 v199, v199, v247
    v_exp_f32 v192, v192
    v_exp_f32 v193, v193
    v_exp_f32 v194, v194
    v_exp_f32 v195, v195
    v_exp_f32 v196, v196
    v_exp_f32 v197, v197
    v_exp_f32 v198, v198
    v_exp_f32 v199, v199
    s_nop 0
    v_cvt_pk_bf16_f32 v192, v192, v193
    v_cvt_pk_bf16_f32 v193, v194, v195
    v_cvt_pk_bf16_f32 v194, v196, v197
    v_cvt_pk_bf16_f32 v195, v198, v199
    s_nop 1
    v_mfma_f32_16x16x32_bf16 v[232:235], v[120:123], v[192:195], v[232:235]
    v_mfma_f32_16x16x32_bf16 v[236:239], v[124:127], v[192:195], v[236:239]
    v_sub_f32 v200, v200, v247
    v_sub_f32 v201, v201, v247
    v_sub_f32 v202, v202, v247
    v_sub_f32 v203, v203, v247
    v_sub_f32 v204, v204, v247
    v_sub_f32 v205, v205, v247
    v_sub_f32 v206, v206, v247
    v_sub_f32 v207, v207, v247
    v_exp_f32 v200, v200
    v_exp_f32 v201, v201
    v_exp_f32 v202, v202
    v_exp_f32 v203, v203
    v_exp_f32 v204, v204
    v_exp_f32 v205, v205
    v_exp_f32 v206, v206
    v_exp_f32 v207, v207
    s_nop 0
    v_cvt_pk_bf16_f32 v200, v200, v201
    v_cvt_pk_bf16_f32 v201, v202, v203
    v_cvt_pk_bf16_f32 v202, v204, v205
    v_cvt_pk_bf16_f32 v203, v206, v207
    s_nop 1
    v_mfma_f32_16x16x32_bf16 v[232:235], v[128:131], v[200:203], v[232:235]
    v_mfma_f32_16x16x32_bf16 v[236:239], v[132:135], v[200:203], v[236:239]
    v_sub_f32 v208, v208, v247
    v_sub_f32 v209, v209, v247
    v_sub_f32 v210, v210, v247
    v_sub_f32 v211, v211, v247
    v_sub_f32 v212, v212, v247
    v_sub_f32 v213, v213, v247
    v_sub_f32 v214, v214, v247
    v_sub_f32 v215, v215, v247
    v_exp_f32 v208, v208
    v_exp_f32 v209, v209
    v_exp_f32 v210, v210
    v_exp_f32 v211, v211
    v_exp_f32 v212, v212
    v_exp_f32 v213, v213
    v_exp_f32 v214, v214
    v_exp_f32 v215, v215
    s_nop 0
    v_cvt_pk_bf16_f32 v208, v208, v209
    v_cvt_pk_bf16_f32 v209, v210, v211
    v_cvt_pk_bf16_f32 v210, v212, v213
    v_cvt_pk_bf16_f32 v211, v214, v215
    s_nop 1
    v_mfma_f32_16x16x32_bf16 v[232:235], v[136:139], v[208:211], v[232:235]
    v_mfma_f32_16x16x32_bf16 v[236:239], v[140:143], v[208:211], v[236:239]
    s_waitcnt vmcnt(0)
    v_sub_f32 v144, v144, v247
    v_sub_f32 v145, v145, v247
    v_sub_f32 v146, v146, v247
    v_sub_f32 v147, v147, v247
    v_sub_f32 v148, v148, v247
    v_sub_f32 v149, v149, v247
    v_sub_f32 v150, v150, v247
    v_sub_f32 v151, v151, v247
    v_exp_f32 v144, v144
    v_exp_f32 v145, v145
    v_exp_f32 v146, v146
    v_exp_f32 v147, v147
    v_exp_f32 v148, v148
    v_exp_f32 v149, v149
    v_exp_f32 v150, v150
    v_exp_f32 v151, v151
    s_nop 0
    v_cvt_pk_bf16_f32 v144, v144, v145
    v_cvt_pk_bf16_f32 v145, v146, v147
    v_cvt_pk_bf16_f32 v146, v148, v149
    v_cvt_pk_bf16_f32 v147, v150, v151
    s_nop 1
    v_mfma_f32_16x16x32_bf16 v[232:235], v[72:75], v[144:147], v[232:235]
    v_mfma_f32_16x16x32_bf16 v[236:239], v[76:79], v[144:147], v[236:239]
    s_cmp_lg_u32 s92, 1
    s_cbranch_scc1 K2_QB_b
    s_movk_i32 s77, 11520
    buffer_load_dwordx4 v[72:75], v241, s[12:15], s77 offen
    s_mov_b64 exec, s[78:79]
    buffer_load_dwordx4 v[76:79], v241, s[12:15], s77 offen offset:1024
    s_mov_b64 exec, -1
K2_QB_b:
    s_nop 7
    ds_bpermute_b32 v248, v250, v236
    s_waitcnt lgkmcnt(0)
    v_rcp_f32 v248, v248
    s_nop 0
    v_mul_f32 v232, v232, v248
    v_mul_f32 v233, v233, v248
    v_mul_f32 v234, v234, v248
    v_mul_f32 v235, v235, v248
    v_mul_f32 v236, v236, v248
    v_mul_f32 v237, v237, v248
    v_mul_f32 v238, v238, v248
    v_mul_f32 v239, v239, v248
    v_cvt_pk_bf16_f32 v232, v232, v233
    v_cvt_pk_bf16_f32 v233, v234, v235
    v_cvt_pk_bf16_f32 v234, v236, v237
    v_cvt_pk_bf16_f32 v235, v238, v239
    v_min_u32 v232, -2, v232
    v_min_u32 v233, -2, v233
    v_min_u32 v234, -2, v234
    v_min_u32 v235, -2, v235
    buffer_store_dwordx2 v[232:233], v244, s[16:19], s91 offen sc1
    s_mov_b64 exec, s[88:89]
    buffer_store_dwordx2 v[234:235], v245, s[16:19], s91 offen sc1
    s_mov_b64 exec, -1
    s_add_u32 s91, s91, 20480
    s_add_u32 s92, s92, 1
    s_cmp_lt_u32 s92, 4
    s_cbranch_scc1 K2_QB
    s_endpgm
K23_F:
    v_and_b32 v226, 63, v0
    s_waitcnt lgkmcnt(0)
    s_mov_b32 s16, s30
    s_and_b32 s17, s31, 0xffff
    s_mov_b32 s18, 0x2000000
    s_mov_b32 s19, 0x00020000
    s_mov_b32 s8, s4
    s_and_b32 s9, s5, 0xffff
    s_mov_b32 s10, 0x280000
    s_mov_b32 s11, 0x00020000
    s_mov_b32 s12, s26
    s_and_b32 s13, s27, 0xffff
    s_mov_b32 s14, 0x280000
    s_mov_b32 s15, 0x00020000
    s_mov_b32 s20, s24
    s_and_b32 s21, s25, 0xffff
    s_mov_b32 s22, 0x500
    s_mov_b32 s23, 0x00020000
    v_lshlrev_b32 v224, 4, v226
    v_add_u32 v225, 4096, v224
    s_mul_i32 s40, s34, 200704
    s_mul_i32 s37, s36, 12288
    s_add_u32 s40, s40, s37
    s_add_u32 s40, s40, 12582912
    s_mul_i32 s41, s36, 491520
    s_mul_i32 s37, s35, 5120
    s_add_u32 s41, s41, s37
    s_add_u32 s41, s41, 20971520
    s_and_b32 s46, s34, 3
    s_mul_i32 s46, s46, 3
    s_add_u32 s46, s46, s35
    s_lshr_b32 s47, s35, 1
    s_add_u32 s46, s46, s47
    s_cmp_ge_u32 s46, 12
    s_cbranch_scc0 K23_R0
    s_sub_u32 s46, s46, 12
K23_R0:
    s_mul_i32 s47, s46, 40960
    s_lshl_b32 s46, s46, 10
    s_barrier
    s_add_u32 s61, s40, s46
    buffer_load_dwordx4 v[80:83], v224, s[16:19], s61 offen
    s_add_u32 s60, s61, 50176
    buffer_load_dwordx4 v[84:87], v224, s[16:19], s60 offen
    s_add_u32 s60, s61, 100352
    buffer_load_dwordx4 v[88:91], v224, s[16:19], s60 offen
    s_add_u32 s60, s61, 150528
    buffer_load_dwordx4 v[92:95], v224, s[16:19], s60 offen
    s_add_u32 s60, s41, s47
    buffer_load_dwordx4 v[96:99], v224, s[16:19], s60 offen offset:0
    buffer_load_dwordx4 v[100:103], v224, s[16:19], s60 offen offset:1024
    buffer_load_dwordx4 v[104:107], v224, s[16:19], s60 offen offset:2048
    buffer_load_dwordx4 v[108:111], v224, s[16:19], s60 offen offset:3072
    buffer_load_dwordx4 v[112:115], v225, s[16:19], s60 offen
    s_add_u32 s46, s46, 1024
    s_add_u32 s47, s47, 40960
    s_cmp_eq_u32 s46, 12288
    s_cselect_b32 s46, 0, s46
    s_cselect_b32 s47, 0, s47
    s_add_u32 s61, s40, s46
    buffer_load_dwordx4 v[116:119], v224, s[16:19], s61 offen
    s_add_u32 s60, s61, 50176
    buffer_load_dwordx4 v[120:123], v224, s[16:19], s60 offen
    s_add_u32 s60, s61, 100352
    buffer_load_dwordx4 v[124:127], v224, s[16:19], s60 offen
    s_add_u32 s60, s61, 150528
    buffer_load_dwordx4 v[128:131], v224, s[16:19], s60 offen
    s_add_u32 s60, s41, s47
    buffer_load_dwordx4 v[132:135], v224, s[16:19], s60 offen offset:0
    buffer_load_dwordx4 v[136:139], v224, s[16:19], s60 offen offset:1024
    buffer_load_dwordx4 v[140:143], v224, s[16:19], s60 offen offset:2048
    buffer_load_dwordx4 v[144:147], v224, s[16:19], s60 offen offset:3072
    buffer_load_dwordx4 v[148:151], v225, s[16:19], s60 offen
    s_add_u32 s46, s46, 1024
    s_add_u32 s47, s47, 40960
    s_cmp_eq_u32 s46, 12288
    s_cselect_b32 s46, 0, s46
    s_cselect_b32 s47, 0, s47
    s_add_u32 s61, s40, s46
    buffer_load_dwordx4 v[152:155], v224, s[16:19], s61 offen
    s_add_u32 s60, s61, 50176
    buffer_load_dwordx4 v[156:159], v224, s[16:19], s60 offen
    s_add_u32 s60, s61, 100352
    buffer_load_dwordx4 v[160:163], v224, s[16:19], s60 offen
    s_add_u32 s60, s61, 150528
    buffer_load_dwordx4 v[164:167], v224, s[16:19], s60 offen
    s_add_u32 s60, s41, s47
    buffer_load_dwordx4 v[168:171], v224, s[16:19], s60 offen offset:0
    buffer_load_dwordx4 v[172:175], v224, s[16:19], s60 offen offset:1024
    buffer_load_dwordx4 v[176:179], v224, s[16:19], s60 offen offset:2048
    buffer_load_dwordx4 v[180:183], v224, s[16:19], s60 offen offset:3072
    buffer_load_dwordx4 v[184:187], v225, s[16:19], s60 offen
    s_add_u32 s46, s46, 1024
    s_add_u32 s47, s47, 40960
    s_cmp_eq_u32 s46, 12288
    s_cselect_b32 s46, 0, s46
    s_cselect_b32 s47, 0, s47
    s_mul_i32 s37, s36, 20480
    v_add_u32 v228, s37, v224
    s_mul_i32 s37, s36, 5120
    v_add_u32 v229, s37, v224
    v_add_u32 v230, 40960, v229
    s_mul_i32 s42, s34, 81920
    s_mul_i32 s37, s36, 20480
    s_add_u32 s42, s42, s37
    s_add_u32 s42, s42, 25165824
    s_mul_i32 s43, s36, 204800
    s_mul_i32 s37, s35, 5120
    s_add_u32 s43, s43, s37
    s_add_u32 s43, s43, 23068672
    v_and_b32 v1, 15, v226
    v_lshrrev_b32 v2, 4, v226
    s_lshl_b32 s37, s34, 6
    s_lshl_b32 s38, s36, 4
    s_add_u32 s37, s37, s38
    v_add_u32 v1, s37, v1
    v_mul_u32_u24 v1, 1280, v1
    s_mul_i32 s38, s35, 160
    v_lshlrev_b32 v2, 3, v2
    v_add_u32 v2, s38, v2
    v_add_u32 v227, v1, v2
    v_mov_b32 v231, v2
    s_add_u32 s61, s40, s46
    buffer_load_dwordx4 v[188:191], v224, s[16:19], s61 offen
    s_add_u32 s60, s61, 50176
    buffer_load_dwordx4 v[192:195], v224, s[16:19], s60 offen
    s_add_u32 s60, s61, 100352
    buffer_load_dwordx4 v[196:199], v224, s[16:19], s60 offen
    s_add_u32 s60, s61, 150528
    buffer_load_dwordx4 v[200:203], v224, s[16:19], s60 offen
    s_add_u32 s60, s41, s47
    buffer_load_dwordx4 v[204:207], v224, s[16:19], s60 offen offset:0
    buffer_load_dwordx4 v[208:211], v224, s[16:19], s60 offen offset:1024
    buffer_load_dwordx4 v[212:215], v224, s[16:19], s60 offen offset:2048
    buffer_load_dwordx4 v[216:219], v224, s[16:19], s60 offen offset:3072
    buffer_load_dwordx4 v[220:223], v225, s[16:19], s60 offen
    s_add_u32 s46, s46, 1024
    s_add_u32 s47, s47, 40960
    s_cmp_eq_u32 s46, 12288
    s_cselect_b32 s46, 0, s46
    s_cselect_b32 s47, 0, s47
    s_waitcnt vmcnt(27)
    v_mfma_f32_16x16x32_bf16 v[0:3], v[96:99], v[80:83], 0
    v_mfma_f32_16x16x32_bf16 v[4:7], v[100:103], v[80:83], 0
    v_mfma_f32_16x16x32_bf16 v[8:11], v[104:107], v[80:83], 0
    v_mfma_f32_16x16x32_bf16 v[12:15], v[108:111], v[80:83], 0
    v_mfma_f32_16x16x32_bf16 v[16:19], v[112:115], v[80:83], 0
    v_mfma_f32_16x16x32_bf16 v[20:23], v[96:99], v[84:87], 0
    v_mfma_f32_16x16x32_bf16 v[24:27], v[100:103], v[84:87], 0
    v_mfma_f32_16x16x32_bf16 v[28:31], v[104:107], v[84:87], 0
    v_mfma_f32_16x16x32_bf16 v[32:35], v[108:111], v[84:87], 0
    v_mfma_f32_16x16x32_bf16 v[36:39], v[112:115], v[84:87], 0
    v_mfma_f32_16x16x32_bf16 v[40:43], v[96:99], v[88:91], 0
    v_mfma_f32_16x16x32_bf16 v[44:47], v[100:103], v[88:91], 0
    v_mfma_f32_16x16x32_bf16 v[48:51], v[104:107], v[88:91], 0
    v_mfma_f32_16x16x32_bf16 v[52:55], v[108:111], v[88:91], 0
    v_mfma_f32_16x16x32_bf16 v[56:59], v[112:115], v[88:91], 0
    v_mfma_f32_16x16x32_bf16 v[60:63], v[96:99], v[92:95], 0
    v_mfma_f32_16x16x32_bf16 v[64:67], v[100:103], v[92:95], 0
    v_mfma_f32_16x16x32_bf16 v[68:71], v[104:107], v[92:95], 0
    v_mfma_f32_16x16x32_bf16 v[72:75], v[108:111], v[92:95], 0
    v_mfma_f32_16x16x32_bf16 v[76:79], v[112:115], v[92:95], 0
    s_add_u32 s61, s40, s46
    buffer_load_dwordx4 v[80:83], v224, s[16:19], s61 offen
    s_add_u32 s60, s61, 50176
    buffer_load_dwordx4 v[84:87], v224, s[16:19], s60 offen
    s_add_u32 s60, s61, 100352
    buffer_load_dwordx4 v[88:91], v224, s[16:19], s60 offen
    s_add_u32 s60, s61, 150528
    buffer_load_dwordx4 v[92:95], v224, s[16:19], s60 offen
    s_add_u32 s60, s41, s47
    buffer_load_dwordx4 v[96:99], v224, s[16:19], s60 offen offset:0
    buffer_load_dwordx4 v[100:103], v224, s[16:19], s60 offen offset:1024
    buffer_load_dwordx4 v[104:107], v224, s[16:19], s60 offen offset:2048
    buffer_load_dwordx4 v[108:111], v224, s[16:19], s60 offen offset:3072
    buffer_load_dwordx4 v[112:115], v225, s[16:19], s60 offen
    s_add_u32 s46, s46, 1024
    s_add_u32 s47, s47, 40960
    s_cmp_eq_u32 s46, 12288
    s_cselect_b32 s46, 0, s46
    s_cselect_b32 s47, 0, s47
    s_waitcnt vmcnt(27)
    v_mfma_f32_16x16x32_bf16 v[0:3], v[132:135], v[116:119], v[0:3]
    v_mfma_f32_16x16x32_bf16 v[4:7], v[136:139], v[116:119], v[4:7]
    v_mfma_f32_16x16x32_bf16 v[8:11], v[140:143], v[116:119], v[8:11]
    v_mfma_f32_16x16x32_bf16 v[12:15], v[144:147], v[116:119], v[12:15]
    v_mfma_f32_16x16x32_bf16 v[16:19], v[148:151], v[116:119], v[16:19]
    v_mfma_f32_16x16x32_bf16 v[20:23], v[132:135], v[120:123], v[20:23]
    v_mfma_f32_16x16x32_bf16 v[24:27], v[136:139], v[120:123], v[24:27]
    v_mfma_f32_16x16x32_bf16 v[28:31], v[140:143], v[120:123], v[28:31]
    v_mfma_f32_16x16x32_bf16 v[32:35], v[144:147], v[120:123], v[32:35]
    v_mfma_f32_16x16x32_bf16 v[36:39], v[148:151], v[120:123], v[36:39]
    v_mfma_f32_16x16x32_bf16 v[40:43], v[132:135], v[124:127], v[40:43]
    v_mfma_f32_16x16x32_bf16 v[44:47], v[136:139], v[124:127], v[44:47]
    v_mfma_f32_16x16x32_bf16 v[48:51], v[140:143], v[124:127], v[48:51]
    v_mfma_f32_16x16x32_bf16 v[52:55], v[144:147], v[124:127], v[52:55]
    v_mfma_f32_16x16x32_bf16 v[56:59], v[148:151], v[124:127], v[56:59]
    v_mfma_f32_16x16x32_bf16 v[60:63], v[132:135], v[128:131], v[60:63]
    v_mfma_f32_16x16x32_bf16 v[64:67], v[136:139], v[128:131], v[64:67]
    v_mfma_f32_16x16x32_bf16 v[68:71], v[140:143], v[128:131], v[68:71]
    v_mfma_f32_16x16x32_bf16 v[72:75], v[144:147], v[128:131], v[72:75]
    v_mfma_f32_16x16x32_bf16 v[76:79], v[148:151], v[128:131], v[76:79]
    s_add_u32 s61, s40, s46
    buffer_load_dwordx4 v[116:119], v224, s[16:19], s61 offen
    s_add_u32 s60, s61, 50176
    buffer_load_dwordx4 v[120:123], v224, s[16:19], s60 offen
    s_add_u32 s60, s61, 100352
    buffer_load_dwordx4 v[124:127], v224, s[16:19], s60 offen
    s_add_u32 s60, s61, 150528
    buffer_load_dwordx4 v[128:131], v224, s[16:19], s60 offen
    s_add_u32 s60, s41, s47
    buffer_load_dwordx4 v[132:135], v224, s[16:19], s60 offen offset:0
    buffer_load_dwordx4 v[136:139], v224, s[16:19], s60 offen offset:1024
    buffer_load_dwordx4 v[140:143], v224, s[16:19], s60 offen offset:2048
    buffer_load_dwordx4 v[144:147], v224, s[16:19], s60 offen offset:3072
    buffer_load_dwordx4 v[148:151], v225, s[16:19], s60 offen
    s_add_u32 s46, s46, 1024
    s_add_u32 s47, s47, 40960
    s_cmp_eq_u32 s46, 12288
    s_cselect_b32 s46, 0, s46
    s_cselect_b32 s47, 0, s47
    s_waitcnt vmcnt(27)
    v_mfma_f32_16x16x32_bf16 v[0:3], v[168:171], v[152:155], v[0:3]
    v_mfma_f32_16x16x32_bf16 v[4:7], v[172:175], v[152:155], v[4:7]
    v_mfma_f32_16x16x32_bf16 v[8:11], v[176:179], v[152:155], v[8:11]
    v_mfma_f32_16x16x32_bf16 v[12:15], v[180:183], v[152:155], v[12:15]
    v_mfma_f32_16x16x32_bf16 v[16:19], v[184:187], v[152:155], v[16:19]
    v_mfma_f32_16x16x32_bf16 v[20:23], v[168:171], v[156:159], v[20:23]
    v_mfma_f32_16x16x32_bf16 v[24:27], v[172:175], v[156:159], v[24:27]
    v_mfma_f32_16x16x32_bf16 v[28:31], v[176:179], v[156:159], v[28:31]
    v_mfma_f32_16x16x32_bf16 v[32:35], v[180:183], v[156:159], v[32:35]
    v_mfma_f32_16x16x32_bf16 v[36:39], v[184:187], v[156:159], v[36:39]
    v_mfma_f32_16x16x32_bf16 v[40:43], v[168:171], v[160:163], v[40:43]
    v_mfma_f32_16x16x32_bf16 v[44:47], v[172:175], v[160:163], v[44:47]
    v_mfma_f32_16x16x32_bf16 v[48:51], v[176:179], v[160:163], v[48:51]
    v_mfma_f32_16x16x32_bf16 v[52:55], v[180:183], v[160:163], v[52:55]
    v_mfma_f32_16x16x32_bf16 v[56:59], v[184:187], v[160:163], v[56:59]
    v_mfma_f32_16x16x32_bf16 v[60:63], v[168:171], v[164:167], v[60:63]
    v_mfma_f32_16x16x32_bf16 v[64:67], v[172:175], v[164:167], v[64:67]
    v_mfma_f32_16x16x32_bf16 v[68:71], v[176:179], v[164:167], v[68:71]
    v_mfma_f32_16x16x32_bf16 v[72:75], v[180:183], v[164:167], v[72:75]
    v_mfma_f32_16x16x32_bf16 v[76:79], v[184:187], v[164:167], v[76:79]
    s_add_u32 s61, s40, s46
    buffer_load_dwordx4 v[152:155], v224, s[16:19], s61 offen
    s_add_u32 s60, s61, 50176
    buffer_load_dwordx4 v[156:159], v224, s[16:19], s60 offen
    s_add_u32 s60, s61, 100352
    buffer_load_dwordx4 v[160:163], v224, s[16:19], s60 offen
    s_add_u32 s60, s61, 150528
    buffer_load_dwordx4 v[164:167], v224, s[16:19], s60 offen
    s_add_u32 s60, s41, s47
    buffer_load_dwordx4 v[168:171], v224, s[16:19], s60 offen offset:0
    buffer_load_dwordx4 v[172:175], v224, s[16:19], s60 offen offset:1024
    buffer_load_dwordx4 v[176:179], v224, s[16:19], s60 offen offset:2048
    buffer_load_dwordx4 v[180:183], v224, s[16:19], s60 offen offset:3072
    buffer_load_dwordx4 v[184:187], v225, s[16:19], s60 offen
    s_add_u32 s46, s46, 1024
    s_add_u32 s47, s47, 40960
    s_cmp_eq_u32 s46, 12288
    s_cselect_b32 s46, 0, s46
    s_cselect_b32 s47, 0, s47
    s_waitcnt vmcnt(27)
    v_mfma_f32_16x16x32_bf16 v[0:3], v[204:207], v[188:191], v[0:3]
    v_mfma_f32_16x16x32_bf16 v[4:7], v[208:211], v[188:191], v[4:7]
    v_mfma_f32_16x16x32_bf16 v[8:11], v[212:215], v[188:191], v[8:11]
    v_mfma_f32_16x16x32_bf16 v[12:15], v[216:219], v[188:191], v[12:15]
    v_mfma_f32_16x16x32_bf16 v[16:19], v[220:223], v[188:191], v[16:19]
    v_mfma_f32_16x16x32_bf16 v[20:23], v[204:207], v[192:195], v[20:23]
    v_mfma_f32_16x16x32_bf16 v[24:27], v[208:211], v[192:195], v[24:27]
    v_mfma_f32_16x16x32_bf16 v[28:31], v[212:215], v[192:195], v[28:31]
    v_mfma_f32_16x16x32_bf16 v[32:35], v[216:219], v[192:195], v[32:35]
    v_mfma_f32_16x16x32_bf16 v[36:39], v[220:223], v[192:195], v[36:39]
    v_mfma_f32_16x16x32_bf16 v[40:43], v[204:207], v[196:199], v[40:43]
    v_mfma_f32_16x16x32_bf16 v[44:47], v[208:211], v[196:199], v[44:47]
    v_mfma_f32_16x16x32_bf16 v[48:51], v[212:215], v[196:199], v[48:51]
    v_mfma_f32_16x16x32_bf16 v[52:55], v[216:219], v[196:199], v[52:55]
    v_mfma_f32_16x16x32_bf16 v[56:59], v[220:223], v[196:199], v[56:59]
    v_mfma_f32_16x16x32_bf16 v[60:63], v[204:207], v[200:203], v[60:63]
    v_mfma_f32_16x16x32_bf16 v[64:67], v[208:211], v[200:203], v[64:67]
    v_mfma_f32_16x16x32_bf16 v[68:71], v[212:215], v[200:203], v[68:71]
    v_mfma_f32_16x16x32_bf16 v[72:75], v[216:219], v[200:203], v[72:75]
    v_mfma_f32_16x16x32_bf16 v[76:79], v[220:223], v[200:203], v[76:79]
    s_mov_b32 s45, 0
K23_FL:
    s_add_u32 s61, s40, s46
    buffer_load_dwordx4 v[188:191], v224, s[16:19], s61 offen
    s_add_u32 s60, s61, 50176
    buffer_load_dwordx4 v[192:195], v224, s[16:19], s60 offen
    s_add_u32 s60, s61, 100352
    buffer_load_dwordx4 v[196:199], v224, s[16:19], s60 offen
    s_add_u32 s60, s61, 150528
    buffer_load_dwordx4 v[200:203], v224, s[16:19], s60 offen
    s_add_u32 s60, s41, s47
    buffer_load_dwordx4 v[204:207], v224, s[16:19], s60 offen offset:0
    buffer_load_dwordx4 v[208:211], v224, s[16:19], s60 offen offset:1024
    buffer_load_dwordx4 v[212:215], v224, s[16:19], s60 offen offset:2048
    buffer_load_dwordx4 v[216:219], v224, s[16:19], s60 offen offset:3072
    buffer_load_dwordx4 v[220:223], v225, s[16:19], s60 offen
    s_add_u32 s46, s46, 1024
    s_add_u32 s47, s47, 40960
    s_cmp_eq_u32 s46, 12288
    s_cselect_b32 s46, 0, s46
    s_cselect_b32 s47, 0, s47
    s_waitcnt vmcnt(27)
    v_mfma_f32_16x16x32_bf16 v[0:3], v[96:99], v[80:83], v[0:3]
    v_mfma_f32_16x16x32_bf16 v[4:7], v[100:103], v[80:83], v[4:7]
    v_mfma_f32_16x16x32_bf16 v[8:11], v[104:107], v[80:83], v[8:11]
    v_mfma_f32_16x16x32_bf16 v[12:15], v[108:111], v[80:83], v[12:15]
    v_mfma_f32_16x16x32_bf16 v[16:19], v[112:115], v[80:83], v[16:19]
    v_mfma_f32_16x16x32_bf16 v[20:23], v[96:99], v[84:87], v[20:23]
    v_mfma_f32_16x16x32_bf16 v[24:27], v[100:103], v[84:87], v[24:27]
    v_mfma_f32_16x16x32_bf16 v[28:31], v[104:107], v[84:87], v[28:31]
    v_mfma_f32_16x16x32_bf16 v[32:35], v[108:111], v[84:87], v[32:35]
    v_mfma_f32_16x16x32_bf16 v[36:39], v[112:115], v[84:87], v[36:39]
    v_mfma_f32_16x16x32_bf16 v[40:43], v[96:99], v[88:91], v[40:43]
    v_mfma_f32_16x16x32_bf16 v[44:47], v[100:103], v[88:91], v[44:47]
    v_mfma_f32_16x16x32_bf16 v[48:51], v[104:107], v[88:91], v[48:51]
    v_mfma_f32_16x16x32_bf16 v[52:55], v[108:111], v[88:91], v[52:55]
    v_mfma_f32_16x16x32_bf16 v[56:59], v[112:115], v[88:91], v[56:59]
    v_mfma_f32_16x16x32_bf16 v[60:63], v[96:99], v[92:95], v[60:63]
    v_mfma_f32_16x16x32_bf16 v[64:67], v[100:103], v[92:95], v[64:67]
    v_mfma_f32_16x16x32_bf16 v[68:71], v[104:107], v[92:95], v[68:71]
    v_mfma_f32_16x16x32_bf16 v[72:75], v[108:111], v[92:95], v[72:75]
    v_mfma_f32_16x16x32_bf16 v[76:79], v[112:115], v[92:95], v[76:79]
    s_cmp_eq_u32 s45, 1
    s_cbranch_scc1 FLs_17
    s_add_u32 s61, s40, s46
    buffer_load_dwordx4 v[80:83], v224, s[16:19], s61 offen
    s_add_u32 s60, s61, 50176
    buffer_load_dwordx4 v[84:87], v224, s[16:19], s60 offen
    s_add_u32 s60, s61, 100352
    buffer_load_dwordx4 v[88:91], v224, s[16:19], s60 offen
    s_add_u32 s60, s61, 150528
    buffer_load_dwordx4 v[92:95], v224, s[16:19], s60 offen
    s_add_u32 s60, s41, s47
    buffer_load_dwordx4 v[96:99], v224, s[16:19], s60 offen offset:0
    buffer_load_dwordx4 v[100:103], v224, s[16:19], s60 offen offset:1024
    buffer_load_dwordx4 v[104:107], v224, s[16:19], s60 offen offset:2048
    buffer_load_dwordx4 v[108:111], v224, s[16:19], s60 offen offset:3072
    buffer_load_dwordx4 v[112:115], v225, s[16:19], s60 offen
    s_add_u32 s46, s46, 1024
    s_add_u32 s47, s47, 40960
    s_cmp_eq_u32 s46, 12288
    s_cselect_b32 s46, 0, s46
    s_cselect_b32 s47, 0, s47
    s_waitcnt vmcnt(27)
    s_branch FLt_18
FLs_17:
    s_waitcnt vmcnt(18)
FLt_18:
    v_mfma_f32_16x16x32_bf16 v[0:3], v[132:135], v[116:119], v[0:3]
    v_mfma_f32_16x16x32_bf16 v[4:7], v[136:139], v[116:119], v[4:7]
    v_mfma_f32_16x16x32_bf16 v[8:11], v[140:143], v[116:119], v[8:11]
    v_mfma_f32_16x16x32_bf16 v[12:15], v[144:147], v[116:119], v[12:15]
    v_mfma_f32_16x16x32_bf16 v[16:19], v[148:151], v[116:119], v[16:19]
    v_mfma_f32_16x16x32_bf16 v[20:23], v[132:135], v[120:123], v[20:23]
    v_mfma_f32_16x16x32_bf16 v[24:27], v[136:139], v[120:123], v[24:27]
    v_mfma_f32_16x16x32_bf16 v[28:31], v[140:143], v[120:123], v[28:31]
    v_mfma_f32_16x16x32_bf16 v[32:35], v[144:147], v[120:123], v[32:35]
    v_mfma_f32_16x16x32_bf16 v[36:39], v[148:151], v[120:123], v[36:39]
    v_mfma_f32_16x16x32_bf16 v[40:43], v[132:135], v[124:127], v[40:43]
    v_mfma_f32_16x16x32_bf16 v[44:47], v[136:139], v[124:127], v[44:47]
    v_mfma_f32_16x16x32_bf16 v[48:51], v[140:143], v[124:127], v[48:51]
    v_mfma_f32_16x16x32_bf16 v[52:55], v[144:147], v[124:127], v[52:55]
    v_mfma_f32_16x16x32_bf16 v[56:59], v[148:151], v[124:127], v[56:59]
    v_mfma_f32_16x16x32_bf16 v[60:63], v[132:135], v[128:131], v[60:63]
    v_mfma_f32_16x16x32_bf16 v[64:67], v[136:139], v[128:131], v[64:67]
    v_mfma_f32_16x16x32_bf16 v[68:71], v[140:143], v[128:131], v[68:71]
    v_mfma_f32_16x16x32_bf16 v[72:75], v[144:147], v[128:131], v[72:75]
    v_mfma_f32_16x16x32_bf16 v[76:79], v[148:151], v[128:131], v[76:79]
    s_cmp_eq_u32 s45, 1
    s_cbranch_scc1 FLs_19
    s_add_u32 s61, s40, s46
    buffer_load_dwordx4 v[116:119], v224, s[16:19], s61 offen
    s_add_u32 s60, s61, 50176
    buffer_load_dwordx4 v[120:123], v224, s[16:19], s60 offen
    s_add_u32 s60, s61, 100352
    buffer_load_dwordx4 v[124:127], v224, s[16:19], s60 offen
    s_add_u32 s60, s61, 150528
    buffer_load_dwordx4 v[128:131], v224, s[16:19], s60 offen
    s_add_u32 s60, s41, s47
    buffer_load_dwordx4 v[132:135], v224, s[16:19], s60 offen offset:0
    buffer_load_dwordx4 v[136:139], v224, s[16:19], s60 offen offset:1024
    buffer_load_dwordx4 v[140:143], v224, s[16:19], s60 offen offset:2048
    buffer_load_dwordx4 v[144:147], v224, s[16:19], s60 offen offset:3072
    buffer_load_dwordx4 v[148:151], v225, s[16:19], s60 offen
    s_add_u32 s46, s46, 1024
    s_add_u32 s47, s47, 40960
    s_cmp_eq_u32 s46, 12288
    s_cselect_b32 s46, 0, s46
    s_cselect_b32 s47, 0, s47
    s_waitcnt vmcnt(27)
    s_branch FLt_20
FLs_19:
    buffer_load_dwordx2 v[232:233], v231, s[20:23], 0 offen offset:0
    buffer_load_dwordx2 v[234:235], v231, s[20:23], 0 offen offset:32
    buffer_load_dwordx2 v[236:237], v231, s[20:23], 0 offen offset:64
    buffer_load_dwordx2 v[238:239], v231, s[20:23], 0 offen offset:96
    buffer_load_dwordx2 v[240:241], v231, s[20:23], 0 offen offset:128
    s_waitcnt vmcnt(14)
FLt_20:
    v_mfma_f32_16x16x32_bf16 v[0:3], v[168:171], v[152:155], v[0:3]
    v_mfma_f32_16x16x32_bf16 v[4:7], v[172:175], v[152:155], v[4:7]
    v_mfma_f32_16x16x32_bf16 v[8:11], v[176:179], v[152:155], v[8:11]
    v_mfma_f32_16x16x32_bf16 v[12:15], v[180:183], v[152:155], v[12:15]
    v_mfma_f32_16x16x32_bf16 v[16:19], v[184:187], v[152:155], v[16:19]
    v_mfma_f32_16x16x32_bf16 v[20:23], v[168:171], v[156:159], v[20:23]
    v_mfma_f32_16x16x32_bf16 v[24:27], v[172:175], v[156:159], v[24:27]
    v_mfma_f32_16x16x32_bf16 v[28:31], v[176:179], v[156:159], v[28:31]
    v_mfma_f32_16x16x32_bf16 v[32:35], v[180:183], v[156:159], v[32:35]
    v_mfma_f32_16x16x32_bf16 v[36:39], v[184:187], v[156:159], v[36:39]
    v_mfma_f32_16x16x32_bf16 v[40:43], v[168:171], v[160:163], v[40:43]
    v_mfma_f32_16x16x32_bf16 v[44:47], v[172:175], v[160:163], v[44:47]
    v_mfma_f32_16x16x32_bf16 v[48:51], v[176:179], v[160:163], v[48:51]
    v_mfma_f32_16x16x32_bf16 v[52:55], v[180:183], v[160:163], v[52:55]
    v_mfma_f32_16x16x32_bf16 v[56:59], v[184:187], v[160:163], v[56:59]
    v_mfma_f32_16x16x32_bf16 v[60:63], v[168:171], v[164:167], v[60:63]
    v_mfma_f32_16x16x32_bf16 v[64:67], v[172:175], v[164:167], v[64:67]
    v_mfma_f32_16x16x32_bf16 v[68:71], v[176:179], v[164:167], v[68:71]
    v_mfma_f32_16x16x32_bf16 v[72:75], v[180:183], v[164:167], v[72:75]
    v_mfma_f32_16x16x32_bf16 v[76:79], v[184:187], v[164:167], v[76:79]
    s_cmp_eq_u32 s45, 1
    s_cbranch_scc1 FLs_21
    s_add_u32 s61, s40, s46
    buffer_load_dwordx4 v[152:155], v224, s[16:19], s61 offen
    s_add_u32 s60, s61, 50176
    buffer_load_dwordx4 v[156:159], v224, s[16:19], s60 offen
    s_add_u32 s60, s61, 100352
    buffer_load_dwordx4 v[160:163], v224, s[16:19], s60 offen
    s_add_u32 s60, s61, 150528
    buffer_load_dwordx4 v[164:167], v224, s[16:19], s60 offen
    s_add_u32 s60, s41, s47
    buffer_load_dwordx4 v[168:171], v224, s[16:19], s60 offen offset:0
    buffer_load_dwordx4 v[172:175], v224, s[16:19], s60 offen offset:1024
    buffer_load_dwordx4 v[176:179], v224, s[16:19], s60 offen offset:2048
    buffer_load_dwordx4 v[180:183], v224, s[16:19], s60 offen offset:3072
    buffer_load_dwordx4 v[184:187], v225, s[16:19], s60 offen
    s_add_u32 s46, s46, 1024
    s_add_u32 s47, s47, 40960
    s_cmp_eq_u32 s46, 12288
    s_cselect_b32 s46, 0, s46
    s_cselect_b32 s47, 0, s47
    s_waitcnt vmcnt(27)
    s_branch FLt_22
FLs_21:
    s_waitcnt vmcnt(5)
FLt_22:
    v_mfma_f32_16x16x32_bf16 v[0:3], v[204:207], v[188:191], v[0:3]
    v_mfma_f32_16x16x32_bf16 v[4:7], v[208:211], v[188:191], v[4:7]
    v_mfma_f32_16x16x32_bf16 v[8:11], v[212:215], v[188:191], v[8:11]
    v_mfma_f32_16x16x32_bf16 v[12:15], v[216:219], v[188:191], v[12:15]
    v_mfma_f32_16x16x32_bf16 v[16:19], v[220:223], v[188:191], v[16:19]
    v_mfma_f32_16x16x32_bf16 v[20:23], v[204:207], v[192:195], v[20:23]
    v_mfma_f32_16x16x32_bf16 v[24:27], v[208:211], v[192:195], v[24:27]
    v_mfma_f32_16x16x32_bf16 v[28:31], v[212:215], v[192:195], v[28:31]
    v_mfma_f32_16x16x32_bf16 v[32:35], v[216:219], v[192:195], v[32:35]
    v_mfma_f32_16x16x32_bf16 v[36:39], v[220:223], v[192:195], v[36:39]
    v_mfma_f32_16x16x32_bf16 v[40:43], v[204:207], v[196:199], v[40:43]
    v_mfma_f32_16x16x32_bf16 v[44:47], v[208:211], v[196:199], v[44:47]
    v_mfma_f32_16x16x32_bf16 v[48:51], v[212:215], v[196:199], v[48:51]
    v_mfma_f32_16x16x32_bf16 v[52:55], v[216:219], v[196:199], v[52:55]
    v_mfma_f32_16x16x32_bf16 v[56:59], v[220:223], v[196:199], v[56:59]
    v_mfma_f32_16x16x32_bf16 v[60:63], v[204:207], v[200:203], v[60:63]
    v_mfma_f32_16x16x32_bf16 v[64:67], v[208:211], v[200:203], v[64:67]
    v_mfma_f32_16x16x32_bf16 v[68:71], v[212:215], v[200:203], v[68:71]
    v_mfma_f32_16x16x32_bf16 v[72:75], v[216:219], v[200:203], v[72:75]
    v_mfma_f32_16x16x32_bf16 v[76:79], v[220:223], v[200:203], v[76:79]
    s_add_u32 s45, s45, 1
    s_cmp_lt_u32 s45, 2
    s_cbranch_scc1 K23_FL
K23_SKIPF:
    buffer_load_dwordx2 v[220:221], v227, s[8:11], 0 offen offset:0
    buffer_load_dwordx2 v[222:223], v227, s[8:11], 0 offen offset:32
    buffer_load_dwordx2 v[250:251], v227, s[8:11], 0 offen offset:64
    buffer_load_dwordx2 v[252:253], v227, s[8:11], 0 offen offset:96
    buffer_load_dwordx2 v[254:255], v227, s[8:11], 0 offen offset:128
    s_nop 7
    ds_write_b128 v228, v[0:3] offset:0
    ds_write_b128 v228, v[4:7] offset:1024
    ds_write_b128 v228, v[8:11] offset:2048
    ds_write_b128 v228, v[12:15] offset:3072
    ds_write_b128 v228, v[16:19] offset:4096
    ds_write_b128 v228, v[20:23] offset:5120
    ds_write_b128 v228, v[24:27] offset:6144
    ds_write_b128 v228, v[28:31] offset:7168
    ds_write_b128 v228, v[32:35] offset:8192
    ds_write_b128 v228, v[36:39] offset:9216
    ds_write_b128 v228, v[40:43] offset:10240
    ds_write_b128 v228, v[44:47] offset:11264
    ds_write_b128 v228, v[48:51] offset:12288
    ds_write_b128 v228, v[52:55] offset:13312
    ds_write_b128 v228, v[56:59] offset:14336
    ds_write_b128 v228, v[60:63] offset:15360
    ds_write_b128 v228, v[64:67] offset:16384
    ds_write_b128 v228, v[68:71] offset:17408
    ds_write_b128 v228, v[72:75] offset:18432
    ds_write_b128 v228, v[76:79] offset:19456
    s_waitcnt lgkmcnt(0)
    v_mov_b32 v248, 102404
    v_mov_b32 v249, 1
    s_mov_b64 exec, 1
    ds_add_u32 v248, v249
FS_23:
    ds_read_b32 v249, v248
    s_waitcnt lgkmcnt(0)
    v_readfirstlane_b32 s62, v249
    s_cmp_ge_u32 s62, 4
    s_cbranch_scc1 FSD_24
    s_sleep 1
    s_branch FS_23
FSD_24:
    s_mov_b64 exec, -1
    ds_read_b128 v[200:203], v229 offset:0
    ds_read_b128 v[204:207], v229 offset:1024
    ds_read_b128 v[208:211], v229 offset:2048
    ds_read_b128 v[212:215], v229 offset:3072
    ds_read_b128 v[216:219], v229 offset:4096
    ds_read_b128 v[20:23], v229 offset:20480
    ds_read_b128 v[24:27], v229 offset:21504
    ds_read_b128 v[28:31], v229 offset:22528
    ds_read_b128 v[32:35], v229 offset:23552
    ds_read_b128 v[36:39], v229 offset:24576
    ds_read_b128 v[40:43], v230 offset:0
    ds_read_b128 v[44:47], v230 offset:1024
    ds_read_b128 v[48:51], v230 offset:2048
    ds_read_b128 v[52:55], v230 offset:3072
    ds_read_b128 v[56:59], v230 offset:4096
    ds_read_b128 v[60:63], v230 offset:20480
    ds_read_b128 v[64:67], v230 offset:21504
    ds_read_b128 v[68:71], v230 offset:22528
    ds_read_b128 v[72:75], v230 offset:23552
    ds_read_b128 v[76:79], v230 offset:24576
    s_waitcnt lgkmcnt(0)
    v_mov_b32 v248, 102408
    v_mov_b32 v249, 1
    s_mov_b64 exec, 1
    ds_add_u32 v248, v249
FS_25:
    ds_read_b32 v249, v248
    s_waitcnt lgkmcnt(0)
    v_readfirstlane_b32 s62, v249
    s_cmp_ge_u32 s62, 4
    s_cbranch_scc1 FSD_26
    s_sleep 1
    s_branch FS_25
FSD_26:
    s_mov_b64 exec, -1
    s_mul_i32 s47, s36, 25600
    s_add_u32 s60, s43, 0
    s_add_u32 m0, s47, 0
    s_nop 0
    buffer_load_dwordx4 v224, s[16:19], s60 offen lds
    s_add_u32 m0, s47, 1024
    s_add_u32 s60, s60, 1024
    buffer_load_dwordx4 v224, s[16:19], s60 offen lds
    s_add_u32 m0, s47, 2048
    s_add_u32 s60, s60, 1024
    buffer_load_dwordx4 v224, s[16:19], s60 offen lds
    s_add_u32 m0, s47, 3072
    s_add_u32 s60, s60, 1024
    buffer_load_dwordx4 v224, s[16:19], s60 offen lds
    s_add_u32 m0, s47, 4096
    s_add_u32 s60, s60, 1024
    buffer_load_dwordx4 v224, s[16:19], s60 offen lds
    s_add_u32 s60, s43, 40960
    s_add_u32 m0, s47, 5120
    s_nop 0
    buffer_load_dwordx4 v224, s[16:19], s60 offen lds
    s_add_u32 m0, s47, 6144
    s_add_u32 s60, s60, 1024
    buffer_load_dwordx4 v224, s[16:19], s60 offen lds
    s_add_u32 m0, s47, 7168
    s_add_u32 s60, s60, 1024
    buffer_load_dwordx4 v224, s[16:19], s60 offen lds
    s_add_u32 m0, s47, 8192
    s_add_u32 s60, s60, 1024
    buffer_load_dwordx4 v224, s[16:19], s60 offen lds
    s_add_u32 m0, s47, 9216
    s_add_u32 s60, s60, 1024
    buffer_load_dwordx4 v224, s[16:19], s60 offen lds
    s_add_u32 s60, s43, 81920
    s_add_u32 m0, s47, 10240
    s_nop 0
    buffer_load_dwordx4 v224, s[16:19], s60 offen lds
    s_add_u32 m0, s47, 11264
    s_add_u32 s60, s60, 1024
    buffer_load_dwordx4 v224, s[16:19], s60 offen lds
    s_add_u32 m0, s47, 12288
    s_add_u32 s60, s60, 1024
    buffer_load_dwordx4 v224, s[16:19], s60 offen lds
    s_add_u32 m0, s47, 13312
    s_add_u32 s60, s60, 1024
    buffer_load_dwordx4 v224, s[16:19], s60 offen lds
    s_add_u32 m0, s47, 14336
    s_add_u32 s60, s60, 1024
    buffer_load_dwordx4 v224, s[16:19], s60 offen lds
    s_add_u32 s60, s43, 122880
    s_add_u32 m0, s47, 15360
    s_nop 0
    buffer_load_dwordx4 v224, s[16:19], s60 offen lds
    s_add_u32 m0, s47, 16384
    s_add_u32 s60, s60, 1024
    buffer_load_dwordx4 v224, s[16:19], s60 offen lds
    s_add_u32 m0, s47, 17408
    s_add_u32 s60, s60, 1024
    buffer_load_dwordx4 v224, s[16:19], s60 offen lds
    s_add_u32 m0, s47, 18432
    s_add_u32 s60, s60, 1024
    buffer_load_dwordx4 v224, s[16:19], s60 offen lds
    s_add_u32 m0, s47, 19456
    s_add_u32 s60, s60, 1024
    buffer_load_dwordx4 v224, s[16:19], s60 offen lds
    s_add_u32 s60, s43, 163840
    s_add_u32 m0, s47, 20480
    s_nop 0
    buffer_load_dwordx4 v224, s[16:19], s60 offen lds
    s_add_u32 m0, s47, 21504
    s_add_u32 s60, s60, 1024
    buffer_load_dwordx4 v224, s[16:19], s60 offen lds
    s_add_u32 m0, s47, 22528
    s_add_u32 s60, s60, 1024
    buffer_load_dwordx4 v224, s[16:19], s60 offen lds
    s_add_u32 m0, s47, 23552
    s_add_u32 s60, s60, 1024
    buffer_load_dwordx4 v224, s[16:19], s60 offen lds
    s_add_u32 m0, s47, 24576
    s_add_u32 s60, s60, 1024
    buffer_load_dwordx4 v224, s[16:19], s60 offen lds
    v_add_f32 v200, v200, v20
    v_add_f32 v201, v201, v21
    v_add_f32 v202, v202, v22
    v_add_f32 v203, v203, v23
    v_add_f32 v204, v204, v24
    v_add_f32 v205, v205, v25
    v_add_f32 v206, v206, v26
    v_add_f32 v207, v207, v27
    v_add_f32 v208, v208, v28
    v_add_f32 v209, v209, v29
    v_add_f32 v210, v210, v30
    v_add_f32 v211, v211, v31
    v_add_f32 v212, v212, v32
    v_add_f32 v213, v213, v33
    v_add_f32 v214, v214, v34
    v_add_f32 v215, v215, v35
    v_add_f32 v216, v216, v36
    v_add_f32 v217, v217, v37
    v_add_f32 v218, v218, v38
    v_add_f32 v219, v219, v39
    v_add_f32 v200, v200, v40
    v_add_f32 v201, v201, v41
    v_add_f32 v202, v202, v42
    v_add_f32 v203, v203, v43
    v_add_f32 v204, v204, v44
    v_add_f32 v205, v205, v45
    v_add_f32 v206, v206, v46
    v_add_f32 v207, v207, v47
    v_add_f32 v208, v208, v48
    v_add_f32 v209, v209, v49
    v_add_f32 v210, v210, v50
    v_add_f32 v211, v211, v51
    v_add_f32 v212, v212, v52
    v_add_f32 v213, v213, v53
    v_add_f32 v214, v214, v54
    v_add_f32 v215, v215, v55
    v_add_f32 v216, v216, v56
    v_add_f32 v217, v217, v57
    v_add_f32 v218, v218, v58
    v_add_f32 v219, v219, v59
    v_add_f32 v200, v200, v60
    v_add_f32 v201, v201, v61
    v_add_f32 v202, v202, v62
    v_add_f32 v203, v203, v63
    v_add_f32 v204, v204, v64
    v_add_f32 v205, v205, v65
    v_add_f32 v206, v206, v66
    v_add_f32 v207, v207, v67
    v_add_f32 v208, v208, v68
    v_add_f32 v209, v209, v69
    v_add_f32 v210, v210, v70
    v_add_f32 v211, v211, v71
    v_add_f32 v212, v212, v72
    v_add_f32 v213, v213, v73
    v_add_f32 v214, v214, v74
    v_add_f32 v215, v215, v75
    v_add_f32 v216, v216, v76
    v_add_f32 v217, v217, v77
    v_add_f32 v218, v218, v78
    v_add_f32 v219, v219, v79
    s_waitcnt vmcnt(30)
    s_mov_b32 s44, 0xbfb8aa3b
    v_lshlrev_b32 v242, 16, v232
    v_and_b32 v243, 0xffff0000, v232
    v_add_f32 v200, v200, v242
    v_mul_f32 v244, s44, v200
    v_exp_f32 v244, v244
    s_nop 0
    v_add_f32 v244, 1.0, v244
    v_rcp_f32 v244, v244
    s_nop 0
    v_mul_f32 v200, v200, v244
    v_add_f32 v201, v201, v243
    v_mul_f32 v245, s44, v201
    v_exp_f32 v245, v245
    s_nop 0
    v_add_f32 v245, 1.0, v245
    v_rcp_f32 v245, v245
    s_nop 0
    v_mul_f32 v201, v201, v245
    v_lshlrev_b32 v242, 16, v233
    v_and_b32 v243, 0xffff0000, v233
    v_add_f32 v202, v202, v242
    v_mul_f32 v244, s44, v202
    v_exp_f32 v244, v244
    s_nop 0
    v_add_f32 v244, 1.0, v244
    v_rcp_f32 v244, v244
    s_nop 0
    v_mul_f32 v202, v202, v244
    v_add_f32 v203, v203, v243
    v_mul_f32 v245, s44, v203
    v_exp_f32 v245, v245
    s_nop 0
    v_add_f32 v245, 1.0, v245
    v_rcp_f32 v245, v245
    s_nop 0
    v_mul_f32 v203, v203, v245
    v_lshlrev_b32 v242, 16, v234
    v_and_b32 v243, 0xffff0000, v234
    v_add_f32 v204, v204, v242
    v_mul_f32 v244, s44, v204
    v_exp_f32 v244, v244
    s_nop 0
    v_add_f32 v244, 1.0, v244
    v_rcp_f32 v244, v244
    s_nop 0
    v_mul_f32 v204, v204, v244
    v_add_f32 v205, v205, v243
    v_mul_f32 v245, s44, v205
    v_exp_f32 v245, v245
    s_nop 0
    v_add_f32 v245, 1.0, v245
    v_rcp_f32 v245, v245
    s_nop 0
    v_mul_f32 v205, v205, v245
    v_lshlrev_b32 v242, 16, v235
    v_and_b32 v243, 0xffff0000, v235
    v_add_f32 v206, v206, v242
    v_mul_f32 v244, s44, v206
    v_exp_f32 v244, v244
    s_nop 0
    v_add_f32 v244, 1.0, v244
    v_rcp_f32 v244, v244
    s_nop 0
    v_mul_f32 v206, v206, v244
    v_add_f32 v207, v207, v243
    v_mul_f32 v245, s44, v207
    v_exp_f32 v245, v245
    s_nop 0
    v_add_f32 v245, 1.0, v245
    v_rcp_f32 v245, v245
    s_nop 0
    v_mul_f32 v207, v207, v245
    v_lshlrev_b32 v242, 16, v236
    v_and_b32 v243, 0xffff0000, v236
    v_add_f32 v208, v208, v242
    v_mul_f32 v244, s44, v208
    v_exp_f32 v244, v244
    s_nop 0
    v_add_f32 v244, 1.0, v244
    v_rcp_f32 v244, v244
    s_nop 0
    v_mul_f32 v208, v208, v244
    v_add_f32 v209, v209, v243
    v_mul_f32 v245, s44, v209
    v_exp_f32 v245, v245
    s_nop 0
    v_add_f32 v245, 1.0, v245
    v_rcp_f32 v245, v245
    s_nop 0
    v_mul_f32 v209, v209, v245
    v_lshlrev_b32 v242, 16, v237
    v_and_b32 v243, 0xffff0000, v237
    v_add_f32 v210, v210, v242
    v_mul_f32 v244, s44, v210
    v_exp_f32 v244, v244
    s_nop 0
    v_add_f32 v244, 1.0, v244
    v_rcp_f32 v244, v244
    s_nop 0
    v_mul_f32 v210, v210, v244
    v_add_f32 v211, v211, v243
    v_mul_f32 v245, s44, v211
    v_exp_f32 v245, v245
    s_nop 0
    v_add_f32 v245, 1.0, v245
    v_rcp_f32 v245, v245
    s_nop 0
    v_mul_f32 v211, v211, v245
    v_lshlrev_b32 v242, 16, v238
    v_and_b32 v243, 0xffff0000, v238
    v_add_f32 v212, v212, v242
    v_mul_f32 v244, s44, v212
    v_exp_f32 v244, v244
    s_nop 0
    v_add_f32 v244, 1.0, v244
    v_rcp_f32 v244, v244
    s_nop 0
    v_mul_f32 v212, v212, v244
    v_add_f32 v213, v213, v243
    v_mul_f32 v245, s44, v213
    v_exp_f32 v245, v245
    s_nop 0
    v_add_f32 v245, 1.0, v245
    v_rcp_f32 v245, v245
    s_nop 0
    v_mul_f32 v213, v213, v245
    v_lshlrev_b32 v242, 16, v239
    v_and_b32 v243, 0xffff0000, v239
    v_add_f32 v214, v214, v242
    v_mul_f32 v244, s44, v214
    v_exp_f32 v244, v244
    s_nop 0
    v_add_f32 v244, 1.0, v244
    v_rcp_f32 v244, v244
    s_nop 0
    v_mul_f32 v214, v214, v244
    v_add_f32 v215, v215, v243
    v_mul_f32 v245, s44, v215
    v_exp_f32 v245, v245
    s_nop 0
    v_add_f32 v245, 1.0, v245
    v_rcp_f32 v245, v245
    s_nop 0
    v_mul_f32 v215, v215, v245
    v_lshlrev_b32 v242, 16, v240
    v_and_b32 v243, 0xffff0000, v240
    v_add_f32 v216, v216, v242
    v_mul_f32 v244, s44, v216
    v_exp_f32 v244, v244
    s_nop 0
    v_add_f32 v244, 1.0, v244
    v_rcp_f32 v244, v244
    s_nop 0
    v_mul_f32 v216, v216, v244
    v_add_f32 v217, v217, v243
    v_mul_f32 v245, s44, v217
    v_exp_f32 v245, v245
    s_nop 0
    v_add_f32 v245, 1.0, v245
    v_rcp_f32 v245, v245
    s_nop 0
    v_mul_f32 v217, v217, v245
    v_lshlrev_b32 v242, 16, v241
    v_and_b32 v243, 0xffff0000, v241
    v_add_f32 v218, v218, v242
    v_mul_f32 v244, s44, v218
    v_exp_f32 v244, v244
    s_nop 0
    v_add_f32 v244, 1.0, v244
    v_rcp_f32 v244, v244
    s_nop 0
    v_mul_f32 v218, v218, v244
    v_add_f32 v219, v219, v243
    v_mul_f32 v245, s44, v219
    v_exp_f32 v245, v245
    s_nop 0
    v_add_f32 v245, 1.0, v245
    v_rcp_f32 v245, v245
    s_nop 0
    v_mul_f32 v219, v219, v245
    v_add_u32 v225, 51200, v224
    s_waitcnt vmcnt(0)
    v_mov_b32 v248, 102412
    v_mov_b32 v249, 1
    s_mov_b64 exec, 1
    ds_add_u32 v248, v249
FS_27:
    ds_read_b32 v249, v248
    s_waitcnt lgkmcnt(0)
    v_readfirstlane_b32 s62, v249
    s_cmp_ge_u32 s62, 4
    s_cbranch_scc1 FSD_28
    s_sleep 1
    s_branch FS_27
FSD_28:
    s_mov_b64 exec, -1
K23_PD:
    s_add_u32 s60, s42, 0
    buffer_load_dwordx4 v[80:83], v224, s[16:19], s60 offen sc1
    s_add_u32 s60, s42, 1024
    buffer_load_dwordx4 v[84:87], v224, s[16:19], s60 offen sc1
    s_add_u32 s60, s42, 2048
    buffer_load_dwordx4 v[88:91], v224, s[16:19], s60 offen sc1
    s_add_u32 s60, s42, 3072
    buffer_load_dwordx4 v[92:95], v224, s[16:19], s60 offen sc1
    s_add_u32 s60, s42, 4096
    buffer_load_dwordx4 v[96:99], v224, s[16:19], s60 offen sc1
    s_add_u32 s60, s42, 5120
    buffer_load_dwordx4 v[100:103], v224, s[16:19], s60 offen sc1
    s_add_u32 s60, s42, 6144
    buffer_load_dwordx4 v[104:107], v224, s[16:19], s60 offen sc1
    s_add_u32 s60, s42, 7168
    buffer_load_dwordx4 v[108:111], v224, s[16:19], s60 offen sc1
    s_add_u32 s60, s42, 8192
    buffer_load_dwordx4 v[112:115], v224, s[16:19], s60 offen sc1
    s_add_u32 s60, s42, 9216
    buffer_load_dwordx4 v[116:119], v224, s[16:19], s60 offen sc1
    s_add_u32 s60, s42, 10240
    buffer_load_dwordx4 v[120:123], v224, s[16:19], s60 offen sc1
    s_add_u32 s60, s42, 11264
    buffer_load_dwordx4 v[124:127], v224, s[16:19], s60 offen sc1
    s_add_u32 s60, s42, 12288
    buffer_load_dwordx4 v[128:131], v224, s[16:19], s60 offen sc1
    s_add_u32 s60, s42, 13312
    buffer_load_dwordx4 v[132:135], v224, s[16:19], s60 offen sc1
    s_add_u32 s60, s42, 14336
    buffer_load_dwordx4 v[136:139], v224, s[16:19], s60 offen sc1
    s_add_u32 s60, s42, 15360
    buffer_load_dwordx4 v[140:143], v224, s[16:19], s60 offen sc1
    s_add_u32 s60, s42, 16384
    buffer_load_dwordx4 v[144:147], v224, s[16:19], s60 offen sc1
    s_add_u32 s60, s42, 17408
    buffer_load_dwordx4 v[148:151], v224, s[16:19], s60 offen sc1
    s_add_u32 s60, s42, 18432
    buffer_load_dwordx4 v[152:155], v224, s[16:19], s60 offen sc1
    s_add_u32 s60, s42, 19456
    buffer_load_dwordx4 v[156:159], v224, s[16:19], s60 offen sc1
K23_GO:
    v_mov_b32 v247, 0
    ds_read_b128 v[160:163], v224 offset:0
    ds_read_b128 v[164:167], v224 offset:1024
    ds_read_b128 v[168:171], v224 offset:2048
    ds_read_b128 v[172:175], v224 offset:3072
    ds_read_b128 v[176:179], v224 offset:4096
    ds_read_b128 v[180:183], v224 offset:5120
    ds_read_b128 v[184:187], v224 offset:6144
    ds_read_b128 v[188:191], v224 offset:7168
    s_waitcnt vmcnt(19)
    s_waitcnt lgkmcnt(7)
    v_mfma_f32_16x16x32_bf16 v[0:3], v[160:163], v[80:83], 0
    ds_read_b128 v[192:195], v224 offset:8192
    s_waitcnt lgkmcnt(7)
    v_mfma_f32_16x16x32_bf16 v[4:7], v[164:167], v[80:83], 0
    ds_read_b128 v[196:199], v224 offset:9216
    v_max3_u32 v247, v247, v80, v81
    s_waitcnt lgkmcnt(7)
    v_mfma_f32_16x16x32_bf16 v[8:11], v[168:171], v[80:83], 0
    ds_read_b128 v[160:163], v224 offset:10240
    v_max3_u32 v247, v247, v82, v83
    s_waitcnt lgkmcnt(7)
    v_mfma_f32_16x16x32_bf16 v[12:15], v[172:175], v[80:83], 0
    ds_read_b128 v[164:167], v224 offset:11264
    s_waitcnt lgkmcnt(7)
    v_mfma_f32_16x16x32_bf16 v[16:19], v[176:179], v[80:83], 0
    ds_read_b128 v[168:171], v224 offset:12288
    s_waitcnt vmcnt(18)
    s_waitcnt lgkmcnt(7)
    v_mfma_f32_16x16x32_bf16 v[0:3], v[180:183], v[84:87], v[0:3]
    ds_read_b128 v[172:175], v224 offset:13312
    s_waitcnt lgkmcnt(7)
    v_mfma_f32_16x16x32_bf16 v[4:7], v[184:187], v[84:87], v[4:7]
    ds_read_b128 v[176:179], v224 offset:14336
    v_max3_u32 v247, v247, v84, v85
    s_waitcnt lgkmcnt(7)
    v_mfma_f32_16x16x32_bf16 v[8:11], v[188:191], v[84:87], v[8:11]
    ds_read_b128 v[180:183], v224 offset:15360
    v_max3_u32 v247, v247, v86, v87
    s_waitcnt lgkmcnt(7)
    v_mfma_f32_16x16x32_bf16 v[12:15], v[192:195], v[84:87], v[12:15]
    ds_read_b128 v[184:187], v224 offset:16384
    s_waitcnt lgkmcnt(7)
    v_mfma_f32_16x16x32_bf16 v[16:19], v[196:199], v[84:87], v[16:19]
    ds_read_b128 v[188:191], v224 offset:17408
    s_waitcnt vmcnt(17)
    s_waitcnt lgkmcnt(7)
    v_mfma_f32_16x16x32_bf16 v[0:3], v[160:163], v[88:91], v[0:3]
    ds_read_b128 v[192:195], v224 offset:18432
    s_waitcnt lgkmcnt(7)
    v_mfma_f32_16x16x32_bf16 v[4:7], v[164:167], v[88:91], v[4:7]
    ds_read_b128 v[196:199], v224 offset:19456
    v_max3_u32 v247, v247, v88, v89
    s_waitcnt lgkmcnt(7)
    v_mfma_f32_16x16x32_bf16 v[8:11], v[168:171], v[88:91], v[8:11]
    ds_read_b128 v[160:163], v224 offset:20480
    v_max3_u32 v247, v247, v90, v91
    s_waitcnt lgkmcnt(7)
    v_mfma_f32_16x16x32_bf16 v[12:15], v[172:175], v[88:91], v[12:15]
    ds_read_b128 v[164:167], v224 offset:21504
    s_waitcnt lgkmcnt(7)
    v_mfma_f32_16x16x32_bf16 v[16:19], v[176:179], v[88:91], v[16:19]
    ds_read_b128 v[168:171], v224 offset:22528
    s_waitcnt vmcnt(16)
    s_waitcnt lgkmcnt(7)
    v_mfma_f32_16x16x32_bf16 v[0:3], v[180:183], v[92:95], v[0:3]
    ds_read_b128 v[172:175], v224 offset:23552
    s_waitcnt lgkmcnt(7)
    v_mfma_f32_16x16x32_bf16 v[4:7], v[184:187], v[92:95], v[4:7]
    ds_read_b128 v[176:179], v224 offset:24576
    v_max3_u32 v247, v247, v92, v93
    s_waitcnt lgkmcnt(7)
    v_mfma_f32_16x16x32_bf16 v[8:11], v[188:191], v[92:95], v[8:11]
    ds_read_b128 v[180:183], v224 offset:25600
    v_max3_u32 v247, v247, v94, v95
    s_waitcnt lgkmcnt(7)
    v_mfma_f32_16x16x32_bf16 v[12:15], v[192:195], v[92:95], v[12:15]
    ds_read_b128 v[184:187], v224 offset:26624
    s_waitcnt lgkmcnt(7)
    v_mfma_f32_16x16x32_bf16 v[16:19], v[196:199], v[92:95], v[16:19]
    ds_read_b128 v[188:191], v224 offset:27648
    s_waitcnt vmcnt(15)
    s_waitcnt lgkmcnt(7)
    v_mfma_f32_16x16x32_bf16 v[0:3], v[160:163], v[96:99], v[0:3]
    ds_read_b128 v[192:195], v224 offset:28672
    s_waitcnt lgkmcnt(7)
    v_mfma_f32_16x16x32_bf16 v[4:7], v[164:167], v[96:99], v[4:7]
    ds_read_b128 v[196:199], v224 offset:29696
    v_max3_u32 v247, v247, v96, v97
    s_waitcnt lgkmcnt(7)
    v_mfma_f32_16x16x32_bf16 v[8:11], v[168:171], v[96:99], v[8:11]
    ds_read_b128 v[160:163], v224 offset:30720
    v_max3_u32 v247, v247, v98, v99
    s_waitcnt lgkmcnt(7)
    v_mfma_f32_16x16x32_bf16 v[12:15], v[172:175], v[96:99], v[12:15]
    ds_read_b128 v[164:167], v224 offset:31744
    s_waitcnt lgkmcnt(7)
    v_mfma_f32_16x16x32_bf16 v[16:19], v[176:179], v[96:99], v[16:19]
    ds_read_b128 v[168:171], v224 offset:32768
    s_waitcnt vmcnt(14)
    s_waitcnt lgkmcnt(7)
    v_mfma_f32_16x16x32_bf16 v[0:3], v[180:183], v[100:103], v[0:3]
    ds_read_b128 v[172:175], v224 offset:33792
    s_waitcnt lgkmcnt(7)
    v_mfma_f32_16x16x32_bf16 v[4:7], v[184:187], v[100:103], v[4:7]
    ds_read_b128 v[176:179], v224 offset:34816
    v_max3_u32 v247, v247, v100, v101
    s_waitcnt lgkmcnt(7)
    v_mfma_f32_16x16x32_bf16 v[8:11], v[188:191], v[100:103], v[8:11]
    ds_read_b128 v[180:183], v224 offset:35840
    v_max3_u32 v247, v247, v102, v103
    s_waitcnt lgkmcnt(7)
    v_mfma_f32_16x16x32_bf16 v[12:15], v[192:195], v[100:103], v[12:15]
    ds_read_b128 v[184:187], v224 offset:36864
    s_waitcnt lgkmcnt(7)
    v_mfma_f32_16x16x32_bf16 v[16:19], v[196:199], v[100:103], v[16:19]
    ds_read_b128 v[188:191], v224 offset:37888
    s_waitcnt vmcnt(13)
    s_waitcnt lgkmcnt(7)
    v_mfma_f32_16x16x32_bf16 v[0:3], v[160:163], v[104:107], v[0:3]
    ds_read_b128 v[192:195], v224 offset:38912
    s_waitcnt lgkmcnt(7)
    v_mfma_f32_16x16x32_bf16 v[4:7], v[164:167], v[104:107], v[4:7]
    ds_read_b128 v[196:199], v224 offset:39936
    v_max3_u32 v247, v247, v104, v105
    s_waitcnt lgkmcnt(7)
    v_mfma_f32_16x16x32_bf16 v[8:11], v[168:171], v[104:107], v[8:11]
    ds_read_b128 v[160:163], v224 offset:40960
    v_max3_u32 v247, v247, v106, v107
    s_waitcnt lgkmcnt(7)
    v_mfma_f32_16x16x32_bf16 v[12:15], v[172:175], v[104:107], v[12:15]
    ds_read_b128 v[164:167], v224 offset:41984
    s_waitcnt lgkmcnt(7)
    v_mfma_f32_16x16x32_bf16 v[16:19], v[176:179], v[104:107], v[16:19]
    ds_read_b128 v[168:171], v224 offset:43008
    s_waitcnt vmcnt(12)
    s_waitcnt lgkmcnt(7)
    v_mfma_f32_16x16x32_bf16 v[0:3], v[180:183], v[108:111], v[0:3]
    ds_read_b128 v[172:175], v224 offset:44032
    s_waitcnt lgkmcnt(7)
    v_mfma_f32_16x16x32_bf16 v[4:7], v[184:187], v[108:111], v[4:7]
    ds_read_b128 v[176:179], v224 offset:45056
    v_max3_u32 v247, v247, v108, v109
    s_waitcnt lgkmcnt(7)
    v_mfma_f32_16x16x32_bf16 v[8:11], v[188:191], v[108:111], v[8:11]
    ds_read_b128 v[180:183], v224 offset:46080
    v_max3_u32 v247, v247, v110, v111
    s_waitcnt lgkmcnt(7)
    v_mfma_f32_16x16x32_bf16 v[12:15], v[192:195], v[108:111], v[12:15]
    ds_read_b128 v[184:187], v224 offset:47104
    s_waitcnt lgkmcnt(7)
    v_mfma_f32_16x16x32_bf16 v[16:19], v[196:199], v[108:111], v[16:19]
    ds_read_b128 v[188:191], v224 offset:48128
    s_waitcnt vmcnt(11)
    s_waitcnt lgkmcnt(7)
    v_mfma_f32_16x16x32_bf16 v[0:3], v[160:163], v[112:115], v[0:3]
    ds_read_b128 v[192:195], v224 offset:49152
    s_waitcnt lgkmcnt(7)
    v_mfma_f32_16x16x32_bf16 v[4:7], v[164:167], v[112:115], v[4:7]
    ds_read_b128 v[196:199], v224 offset:50176
    v_max3_u32 v247, v247, v112, v113
    s_waitcnt lgkmcnt(7)
    v_mfma_f32_16x16x32_bf16 v[8:11], v[168:171], v[112:115], v[8:11]
    ds_read_b128 v[160:163], v225 offset:0
    v_max3_u32 v247, v247, v114, v115
    s_waitcnt lgkmcnt(7)
    v_mfma_f32_16x16x32_bf16 v[12:15], v[172:175], v[112:115], v[12:15]
    ds_read_b128 v[164:167], v225 offset:1024
    s_waitcnt lgkmcnt(7)
    v_mfma_f32_16x16x32_bf16 v[16:19], v[176:179], v[112:115], v[16:19]
    ds_read_b128 v[168:171], v225 offset:2048
    s_waitcnt vmcnt(10)
    s_waitcnt lgkmcnt(7)
    v_mfma_f32_16x16x32_bf16 v[0:3], v[180:183], v[116:119], v[0:3]
    ds_read_b128 v[172:175], v225 offset:3072
    s_waitcnt lgkmcnt(7)
    v_mfma_f32_16x16x32_bf16 v[4:7], v[184:187], v[116:119], v[4:7]
    ds_read_b128 v[176:179], v225 offset:4096
    v_max3_u32 v247, v247, v116, v117
    s_waitcnt lgkmcnt(7)
    v_mfma_f32_16x16x32_bf16 v[8:11], v[188:191], v[116:119], v[8:11]
    ds_read_b128 v[180:183], v225 offset:5120
    v_max3_u32 v247, v247, v118, v119
    s_waitcnt lgkmcnt(7)
    v_mfma_f32_16x16x32_bf16 v[12:15], v[192:195], v[116:119], v[12:15]
    ds_read_b128 v[184:187], v225 offset:6144
    s_waitcnt lgkmcnt(7)
    v_mfma_f32_16x16x32_bf16 v[16:19], v[196:199], v[116:119], v[16:19]
    ds_read_b128 v[188:191], v225 offset:7168
    s_waitcnt vmcnt(9)
    s_waitcnt lgkmcnt(7)
    v_mfma_f32_16x16x32_bf16 v[0:3], v[160:163], v[120:123], v[0:3]
    ds_read_b128 v[192:195], v225 offset:8192
    s_waitcnt lgkmcnt(7)
    v_mfma_f32_16x16x32_bf16 v[4:7], v[164:167], v[120:123], v[4:7]
    ds_read_b128 v[196:199], v225 offset:9216
    v_max3_u32 v247, v247, v120, v121
    s_waitcnt lgkmcnt(7)
    v_mfma_f32_16x16x32_bf16 v[8:11], v[168:171], v[120:123], v[8:11]
    ds_read_b128 v[160:163], v225 offset:10240
    v_max3_u32 v247, v247, v122, v123
    s_waitcnt lgkmcnt(7)
    v_mfma_f32_16x16x32_bf16 v[12:15], v[172:175], v[120:123], v[12:15]
    ds_read_b128 v[164:167], v225 offset:11264
    s_waitcnt lgkmcnt(7)
    v_mfma_f32_16x16x32_bf16 v[16:19], v[176:179], v[120:123], v[16:19]
    ds_read_b128 v[168:171], v225 offset:12288
    s_waitcnt vmcnt(8)
    s_waitcnt lgkmcnt(7)
    v_mfma_f32_16x16x32_bf16 v[0:3], v[180:183], v[124:127], v[0:3]
    ds_read_b128 v[172:175], v225 offset:13312
    s_waitcnt lgkmcnt(7)
    v_mfma_f32_16x16x32_bf16 v[4:7], v[184:187], v[124:127], v[4:7]
    ds_read_b128 v[176:179], v225 offset:14336
    v_max3_u32 v247, v247, v124, v125
    s_waitcnt lgkmcnt(7)
    v_mfma_f32_16x16x32_bf16 v[8:11], v[188:191], v[124:127], v[8:11]
    ds_read_b128 v[180:183], v225 offset:15360
    v_max3_u32 v247, v247, v126, v127
    s_waitcnt lgkmcnt(7)
    v_mfma_f32_16x16x32_bf16 v[12:15], v[192:195], v[124:127], v[12:15]
    ds_read_b128 v[184:187], v225 offset:16384
    s_waitcnt lgkmcnt(7)
    v_mfma_f32_16x16x32_bf16 v[16:19], v[196:199], v[124:127], v[16:19]
    ds_read_b128 v[188:191], v225 offset:17408
    s_waitcnt vmcnt(7)
    s_waitcnt lgkmcnt(7)
    v_mfma_f32_16x16x32_bf16 v[0:3], v[160:163], v[128:131], v[0:3]
    ds_read_b128 v[192:195], v225 offset:18432
    s_waitcnt lgkmcnt(7)
    v_mfma_f32_16x16x32_bf16 v[4:7], v[164:167], v[128:131], v[4:7]
    ds_read_b128 v[196:199], v225 offset:19456
    v_max3_u32 v247, v247, v128, v129
    s_waitcnt lgkmcnt(7)
    v_mfma_f32_16x16x32_bf16 v[8:11], v[168:171], v[128:131], v[8:11]
    ds_read_b128 v[160:163], v225 offset:20480
    v_max3_u32 v247, v247, v130, v131
    s_waitcnt lgkmcnt(7)
    v_mfma_f32_16x16x32_bf16 v[12:15], v[172:175], v[128:131], v[12:15]
    ds_read_b128 v[164:167], v225 offset:21504
    s_waitcnt lgkmcnt(7)
    v_mfma_f32_16x16x32_bf16 v[16:19], v[176:179], v[128:131], v[16:19]
    ds_read_b128 v[168:171], v225 offset:22528
    s_waitcnt vmcnt(6)
    s_waitcnt lgkmcnt(7)
    v_mfma_f32_16x16x32_bf16 v[0:3], v[180:183], v[132:135], v[0:3]
    ds_read_b128 v[172:175], v225 offset:23552
    s_waitcnt lgkmcnt(7)
    v_mfma_f32_16x16x32_bf16 v[4:7], v[184:187], v[132:135], v[4:7]
    ds_read_b128 v[176:179], v225 offset:24576
    v_max3_u32 v247, v247, v132, v133
    s_waitcnt lgkmcnt(7)
    v_mfma_f32_16x16x32_bf16 v[8:11], v[188:191], v[132:135], v[8:11]
    ds_read_b128 v[180:183], v225 offset:25600
    v_max3_u32 v247, v247, v134, v135
    s_waitcnt lgkmcnt(7)
    v_mfma_f32_16x16x32_bf16 v[12:15], v[192:195], v[132:135], v[12:15]
    ds_read_b128 v[184:187], v225 offset:26624
    s_waitcnt lgkmcnt(7)
    v_mfma_f32_16x16x32_bf16 v[16:19], v[196:199], v[132:135], v[16:19]
    ds_read_b128 v[188:191], v225 offset:27648
    s_waitcnt vmcnt(5)
    s_waitcnt lgkmcnt(7)
    v_mfma_f32_16x16x32_bf16 v[0:3], v[160:163], v[136:139], v[0:3]
    ds_read_b128 v[192:195], v225 offset:28672
    s_waitcnt lgkmcnt(7)
    v_mfma_f32_16x16x32_bf16 v[4:7], v[164:167], v[136:139], v[4:7]
    ds_read_b128 v[196:199], v225 offset:29696
    v_max3_u32 v247, v247, v136, v137
    s_waitcnt lgkmcnt(7)
    v_mfma_f32_16x16x32_bf16 v[8:11], v[168:171], v[136:139], v[8:11]
    ds_read_b128 v[160:163], v225 offset:30720
    v_max3_u32 v247, v247, v138, v139
    s_waitcnt lgkmcnt(7)
    v_mfma_f32_16x16x32_bf16 v[12:15], v[172:175], v[136:139], v[12:15]
    ds_read_b128 v[164:167], v225 offset:31744
    s_waitcnt lgkmcnt(7)
    v_mfma_f32_16x16x32_bf16 v[16:19], v[176:179], v[136:139], v[16:19]
    ds_read_b128 v[168:171], v225 offset:32768
    s_waitcnt vmcnt(4)
    s_waitcnt lgkmcnt(7)
    v_mfma_f32_16x16x32_bf16 v[0:3], v[180:183], v[140:143], v[0:3]
    ds_read_b128 v[172:175], v225 offset:33792
    s_waitcnt lgkmcnt(7)
    v_mfma_f32_16x16x32_bf16 v[4:7], v[184:187], v[140:143], v[4:7]
    ds_read_b128 v[176:179], v225 offset:34816
    v_max3_u32 v247, v247, v140, v141
    s_waitcnt lgkmcnt(7)
    v_mfma_f32_16x16x32_bf16 v[8:11], v[188:191], v[140:143], v[8:11]
    ds_read_b128 v[180:183], v225 offset:35840
    v_max3_u32 v247, v247, v142, v143
    s_waitcnt lgkmcnt(7)
    v_mfma_f32_16x16x32_bf16 v[12:15], v[192:195], v[140:143], v[12:15]
    ds_read_b128 v[184:187], v225 offset:36864
    s_waitcnt lgkmcnt(7)
    v_mfma_f32_16x16x32_bf16 v[16:19], v[196:199], v[140:143], v[16:19]
    ds_read_b128 v[188:191], v225 offset:37888
    s_waitcnt vmcnt(3)
    s_waitcnt lgkmcnt(7)
    v_mfma_f32_16x16x32_bf16 v[0:3], v[160:163], v[144:147], v[0:3]
    ds_read_b128 v[192:195], v225 offset:38912
    s_waitcnt lgkmcnt(7)
    v_mfma_f32_16x16x32_bf16 v[4:7], v[164:167], v[144:147], v[4:7]
    ds_read_b128 v[196:199], v225 offset:39936
    v_max3_u32 v247, v247, v144, v145
    s_waitcnt lgkmcnt(7)
    v_mfma_f32_16x16x32_bf16 v[8:11], v[168:171], v[144:147], v[8:11]
    ds_read_b128 v[160:163], v225 offset:40960
    v_max3_u32 v247, v247, v146, v147
    s_waitcnt lgkmcnt(7)
    v_mfma_f32_16x16x32_bf16 v[12:15], v[172:175], v[144:147], v[12:15]
    ds_read_b128 v[164:167], v225 offset:41984
    s_waitcnt lgkmcnt(7)
    v_mfma_f32_16x16x32_bf16 v[16:19], v[176:179], v[144:147], v[16:19]
    ds_read_b128 v[168:171], v225 offset:43008
    s_waitcnt vmcnt(2)
    s_waitcnt lgkmcnt(7)
    v_mfma_f32_16x16x32_bf16 v[0:3], v[180:183], v[148:151], v[0:3]
    ds_read_b128 v[172:175], v225 offset:44032
    s_waitcnt lgkmcnt(7)
    v_mfma_f32_16x16x32_bf16 v[4:7], v[184:187], v[148:151], v[4:7]
    ds_read_b128 v[176:179], v225 offset:45056
    v_max3_u32 v247, v247, v148, v149
    s_waitcnt lgkmcnt(7)
    v_mfma_f32_16x16x32_bf16 v[8:11], v[188:191], v[148:151], v[8:11]
    ds_read_b128 v[180:183], v225 offset:46080
    v_max3_u32 v247, v247, v150, v151
    s_waitcnt lgkmcnt(7)
    v_mfma_f32_16x16x32_bf16 v[12:15], v[192:195], v[148:151], v[12:15]
    ds_read_b128 v[184:187], v225 offset:47104
    s_waitcnt lgkmcnt(7)
    v_mfma_f32_16x16x32_bf16 v[16:19], v[196:199], v[148:151], v[16:19]
    ds_read_b128 v[188:191], v225 offset:48128
    s_waitcnt vmcnt(1)
    s_waitcnt lgkmcnt(7)
    v_mfma_f32_16x16x32_bf16 v[0:3], v[160:163], v[152:155], v[0:3]
    ds_read_b128 v[192:195], v225 offset:49152
    s_waitcnt lgkmcnt(7)
    v_mfma_f32_16x16x32_bf16 v[4:7], v[164:167], v[152:155], v[4:7]
    ds_read_b128 v[196:199], v225 offset:50176
    v_max3_u32 v247, v247, v152, v153
    s_waitcnt lgkmcnt(7)
    v_mfma_f32_16x16x32_bf16 v[8:11], v[168:171], v[152:155], v[8:11]
    v_max3_u32 v247, v247, v154, v155
    s_waitcnt lgkmcnt(6)
    v_mfma_f32_16x16x32_bf16 v[12:15], v[172:175], v[152:155], v[12:15]
    s_waitcnt lgkmcnt(5)
    v_mfma_f32_16x16x32_bf16 v[16:19], v[176:179], v[152:155], v[16:19]
    s_waitcnt vmcnt(0)
    s_waitcnt lgkmcnt(4)
    v_mfma_f32_16x16x32_bf16 v[0:3], v[180:183], v[156:159], v[0:3]
    s_waitcnt lgkmcnt(3)
    v_mfma_f32_16x16x32_bf16 v[4:7], v[184:187], v[156:159], v[4:7]
    v_max3_u32 v247, v247, v156, v157
    s_waitcnt lgkmcnt(2)
    v_mfma_f32_16x16x32_bf16 v[8:11], v[188:191], v[156:159], v[8:11]
    v_max3_u32 v247, v247, v158, v159
    s_waitcnt lgkmcnt(1)
    v_mfma_f32_16x16x32_bf16 v[12:15], v[192:195], v[156:159], v[12:15]
    s_waitcnt lgkmcnt(0)
    v_mfma_f32_16x16x32_bf16 v[16:19], v[196:199], v[156:159], v[16:19]
    v_cmp_eq_u32 vcc, -1, v247
    s_cbranch_vccz K23_OK
    s_sleep 1
    s_branch K23_PD
K23_OK:
    s_nop 7
    v_lshlrev_b32 v242, 16, v220
    v_and_b32 v243, 0xffff0000, v220
    v_fma_f32 v242, v0, v200, v242
    v_fma_f32 v243, v1, v201, v243
    v_cvt_pk_bf16_f32 v246, v242, v243
    v_lshlrev_b32 v242, 16, v221
    v_and_b32 v243, 0xffff0000, v221
    v_fma_f32 v242, v2, v202, v242
    v_fma_f32 v243, v3, v203, v243
    v_cvt_pk_bf16_f32 v247, v242, v243
    buffer_store_dwordx2 v[246:247], v227, s[12:15], 0 offen offset:0
    s_nop 1
    v_lshlrev_b32 v242, 16, v222
    v_and_b32 v243, 0xffff0000, v222
    v_fma_f32 v242, v4, v204, v242
    v_fma_f32 v243, v5, v205, v243
    v_cvt_pk_bf16_f32 v246, v242, v243
    v_lshlrev_b32 v242, 16, v223
    v_and_b32 v243, 0xffff0000, v223
    v_fma_f32 v242, v6, v206, v242
    v_fma_f32 v243, v7, v207, v243
    v_cvt_pk_bf16_f32 v247, v242, v243
    buffer_store_dwordx2 v[246:247], v227, s[12:15], 0 offen offset:32
    s_nop 1
    v_lshlrev_b32 v242, 16, v250
    v_and_b32 v243, 0xffff0000, v250
    v_fma_f32 v242, v8, v208, v242
    v_fma_f32 v243, v9, v209, v243
    v_cvt_pk_bf16_f32 v246, v242, v243
    v_lshlrev_b32 v242, 16, v251
    v_and_b32 v243, 0xffff0000, v251
    v_fma_f32 v242, v10, v210, v242
    v_fma_f32 v243, v11, v211, v243
    v_cvt_pk_bf16_f32 v247, v242, v243
    buffer_store_dwordx2 v[246:247], v227, s[12:15], 0 offen offset:64
    s_nop 1
    v_lshlrev_b32 v242, 16, v252
    v_and_b32 v243, 0xffff0000, v252
    v_fma_f32 v242, v12, v212, v242
    v_fma_f32 v243, v13, v213, v243
    v_cvt_pk_bf16_f32 v246, v242, v243
    v_lshlrev_b32 v242, 16, v253
    v_and_b32 v243, 0xffff0000, v253
    v_fma_f32 v242, v14, v214, v242
    v_fma_f32 v243, v15, v215, v243
    v_cvt_pk_bf16_f32 v247, v242, v243
    buffer_store_dwordx2 v[246:247], v227, s[12:15], 0 offen offset:96
    s_nop 1
    v_lshlrev_b32 v242, 16, v254
    v_and_b32 v243, 0xffff0000, v254
    v_fma_f32 v242, v16, v216, v242
    v_fma_f32 v243, v17, v217, v243
    v_cvt_pk_bf16_f32 v246, v242, v243
    v_lshlrev_b32 v242, 16, v255
    v_and_b32 v243, 0xffff0000, v255
    v_fma_f32 v242, v18, v218, v242
    v_fma_f32 v243, v19, v219, v243
    v_cvt_pk_bf16_f32 v247, v242, v243
    buffer_store_dwordx2 v[246:247], v227, s[12:15], 0 offen offset:128
    s_nop 1
K23_END:
    s_endpgm
.section .rodata,"a"
.p2align 6
.amdhsa_kernel k1_kernel
  .amdhsa_next_free_vgpr 256
  .amdhsa_next_free_sgpr 102
  .amdhsa_accum_offset 256
  .amdhsa_group_segment_fixed_size 0
  .amdhsa_kernarg_size 88
  .amdhsa_user_sgpr_count 2
  .amdhsa_user_sgpr_kernarg_segment_ptr 1
  .amdhsa_system_sgpr_workgroup_id_x 1
.end_amdhsa_kernel
.p2align 6
.amdhsa_kernel k23_kernel
  .amdhsa_next_free_vgpr 256
  .amdhsa_next_free_sgpr 102
  .amdhsa_accum_offset 256
  .amdhsa_group_segment_fixed_size 0
  .amdhsa_kernarg_size 88
  .amdhsa_user_sgpr_count 2
  .amdhsa_user_sgpr_kernarg_segment_ptr 1
  .amdhsa_system_sgpr_workgroup_id_x 1
.end_amdhsa_kernel
```
